```python
import torch

def _softmax(x, axis=-1):
    return torch.softmax(x, dim=axis)

def _gelu(x):
    return torch.nn.functional.gelu(x, approximate='tanh')

def _silu(x):
    return torch.nn.functional.silu(x)

def _sigmoid(x):
    return torch.sigmoid(x)

def _layernorm(x, axis=-1, eps=1e-05):
    m = x.mean(dim=axis, keepdim=True)
    v = x.var(dim=axis, keepdim=True, unbiased=False)
    return (x - m) / torch.sqrt(v + eps)

def _scatter_add(tgt, idx, src, axis=0):
    return tgt.clone().index_add_(axis, idx, src)

def _segment_sum(src, seg, n):
    out = torch.zeros((n,) + src.shape[1:], dtype=src.dtype)
    return out.index_add_(0, seg, src)

def _pad(x, pw):
    flat = tuple((v for pair in reversed(pw) for v in pair))
    return torch.nn.functional.pad(x, flat)
kernel_name = 'standalone__kv_cache_quant_pre_rope_vs_post_rope__prompt'

def setup_inputs():

    _w = lambda a: (lambda t: t.to(torch.bfloat16) if t.is_floating_point() else t)(torch.as_tensor(a))
    B, Sq, Skv = (1, 2048, 2048)
    H, Dh0 = (8, 256)
    G = -1 if -1 > 0 else Dh0
    G = max(2, G // 2 * 2)
    Dh = max(G, Dh0 // G * G)
    Skv = max(Skv, Sq)
    ng = Dh // G
    bits = 8 if 8 > 1 else 4
    bits = max(2, min(8, bits))
    qmax = (1 << bits) - 1
    half = Dh // 2
    inv = 1.0 / 10000.0 ** (torch.arange(half) / max(1, half))
    ang_k = torch.arange(Skv)[:, None] * inv[None, :]
    ang_q = torch.arange(Skv - Sq, Skv)[:, None] * inv[None, :]
    kc = torch.cat([torch.cos(ang_k), torch.cos(ang_k)], dim=-1)
    ks = torch.cat([torch.sin(ang_k), torch.sin(ang_k)], dim=-1)
    qc = torch.cat([torch.cos(ang_q), torch.cos(ang_q)], dim=-1)
    qs = torch.cat([torch.sin(ang_q), torch.sin(ang_q)], dim=-1)
    qk_i = torch.randint(0, qmax + 1, (B, H, Skv, Dh)).to(torch.int32)
    qv_i = torch.randint(0, qmax + 1, (B, H, Skv, Dh)).to(torch.int32)
    ksc = torch.abs((lambda *s: torch.randn(*s, dtype=torch.bfloat16) * 0.05)(B, H, Skv, ng)) * 0.1 + 0.01
    kzp = torch.full((B, H, Skv, ng), qmax / 2.0)
    vsc = torch.abs((lambda *s: torch.randn(*s, dtype=torch.bfloat16) * 0.05)(B, H, Skv, ng)) * 0.1 + 0.01
    vzp = torch.full((B, H, Skv, ng), qmax / 2.0)
    return {'q': _w((lambda *s: torch.randn(*s, dtype=torch.bfloat16) * 0.8)(B, H, Sq, Dh) * 0.5), 'qk': _w(qk_i), 'k_scales': _w(ksc), 'k_zeros': _w(kzp), 'qv': _w(qv_i), 'v_scales': _w(vsc), 'v_zeros': _w(vzp), 'q_cos': _w(qc), 'q_sin': _w(qs), 'k_cos': _w(kc), 'k_sin': _w(ks)}

def reference(q, qk, k_scales, k_zeros, qv, v_scales, v_zeros, q_cos, q_sin, k_cos, k_sin):
    B, H, Sq, Dh = q.shape
    ng = k_scales.shape[-1]
    G = Dh // ng
    half = Dh // 2
    ks = (lambda x, n, axis: torch.repeat_interleave(x, n, dim=axis))(k_scales, G, axis=-1)
    kz = (lambda x, n, axis: torch.repeat_interleave(x, n, dim=axis))(k_zeros, G, axis=-1)
    k = ((lambda x, dt: x.to(dt))(qk, q.dtype) - kz) * ks
    vs = (lambda x, n, axis: torch.repeat_interleave(x, n, dim=axis))(v_scales, G, axis=-1)
    vz = (lambda x, n, axis: torch.repeat_interleave(x, n, dim=axis))(v_zeros, G, axis=-1)
    v = ((lambda x, dt: x.to(dt))(qv, q.dtype) - vz) * vs
    k1 = k[..., :half].clone()
    k2 = k[..., half:].clone()
    krh = torch.concatenate([-k2, k1], axis=-1)
    kr = k * k_cos[None, None, :, :] + krh * k_sin[None, None, :, :]
    q1 = q[..., :half].clone()
    q2 = q[..., half:].clone()
    qrh = torch.concatenate([-q2, q1], axis=-1)
    qr = q * q_cos[None, None, :, :] + qrh * q_sin[None, None, :, :]
    logits = torch.einsum('bhqd,bhkd->bhqk', qr, kr) * float(Dh) ** (-0.5)
    attn = _softmax(logits, axis=-1)
    out = torch.einsum('bhqk,bhkd->bhqd', attn, v)
    return out
```

```asm
; @launch grid=(256,1,1) block=(256,1,1) lds=83968
.amdgcn_target "amdgcn-amd-amdhsa--gfx950"
.text
.globl standalone__kv_cache_quant_pre_rope_vs_post_rope__prompt_kernel
.p2align 8
.type standalone__kv_cache_quant_pre_rope_vs_post_rope__prompt_kernel,@function
standalone__kv_cache_quant_pre_rope_vs_post_rope__prompt_kernel:
    s_cmp_ge_u32 s2, 256
    s_cbranch_scc1 L_done
    s_load_dwordx16 s[40:55], s[0:1], 0
    s_load_dwordx2 s[62:63], s[0:1], 88
    s_load_dwordx4 s[64:67], s[0:1], 96
    s_getpc_b64 s[4:5]
L_pc:
    v_lshlrev_b32 v30, 7, v0
    v_min_u32 v30, L_code_end-L_pc-4, v30
    global_load_dword v31, v30, s[4:5]
    s_and_b32 s99, s2, 7
    s_lshr_b32 s90, s2, 3
    v_lshrrev_b32 v1, 6, v0
    v_and_b32 v2, 15, v0
    v_bfe_u32 v3, v0, 4, 2
    v_readfirstlane_b32 s33, v1
    v_and_b32 v4, 7, v0
    v_bfe_u32 v249, v0, 3, 3
    v_lshlrev_b32 v248, 10, v249
    v_lshl_add_u32 v248, v4, 5, v248
    v_lshrrev_b32 v5, 2, v4
    v_lshlrev_b32 v250, 10, v5
    v_and_b32 v5, 3, v4
    v_lshl_add_u32 v250, v5, 8, v250
    v_lshl_add_u32 v250, v249, 4, v250
    v_and_b32 v4, 15, v0
    v_bfe_u32 v5, v0, 4, 2
    v_lshlrev_b32 v251, 12, v5
    v_lshl_add_u32 v251, v4, 4, v251
    v_and_b32 v252, 63, v0
    v_lshlrev_b32 v252, 4, v252
    v_lshl_add_u32 v4, v1, 4, v3
    v_lshlrev_b32 v14, 9, v4
    v_lshl_add_u32 v14, v2, 4, v14
    s_and_b32 s92, s33, 1
    s_lshl_b32 s93, s90, 1
    s_add_u32 s92, s92, s93
    s_lshl_b32 s68, s92, 3
    s_add_u32 s68, s68, 0
    s_lshr_b32 s69, s92, 2
    s_add_u32 s69, s69, 0
    s_and_b32 s70, s92, 3
    s_lshl_b32 s96, s99, 21
    s_waitcnt lgkmcnt(0)
    s_add_u32 s56, s42, s96
    s_addc_u32 s57, s43, 0
    s_mov_b32 s58, 2097152
    s_mov_b32 s59, 0x20000
    s_lshl_b32 s92, s99, 20
    s_lshl_b32 s95, s90, 15
    s_add_u32 s94, s92, s95
    s_add_u32 s24, s62, s94
    s_addc_u32 s25, s63, 0
    s_mov_b32 s26, 32768
    s_mov_b32 s27, 0x20000
    s_add_u32 s60, s48, s96
    s_addc_u32 s61, s49, 0
    s_mov_b32 s62, 2097152
    s_mov_b32 s63, 0x20000
    s_add_u32 s12, s40, s94
    s_addc_u32 s13, s41, 0
    s_mov_b32 s14, 32768
    s_mov_b32 s15, 0x20000
    s_cmp_ge_u32 s33, 2
    s_cbranch_scc1 L_B_i0
    s_lshl_b32 s92, s68, 10
    buffer_load_dwordx4 v[16:19], v248, s[56:59], s92 offen offset:0
    buffer_load_dwordx4 v[20:23], v248, s[56:59], s92 offen offset:16
    buffer_load_dwordx4 v[24:27], v248, s[56:59], s92 offen offset:256
    buffer_load_dwordx4 v[28:31], v248, s[56:59], s92 offen offset:272
    buffer_load_dwordx4 v[32:35], v248, s[56:59], s92 offen offset:512
    buffer_load_dwordx4 v[36:39], v248, s[56:59], s92 offen offset:528
    buffer_load_dwordx4 v[40:43], v248, s[56:59], s92 offen offset:768
    buffer_load_dwordx4 v[44:47], v248, s[56:59], s92 offen offset:784
    s_lshl_b32 s94, s99, 12
    s_add_u32 s72, s44, s94
    s_addc_u32 s73, s45, 0
    s_mov_b32 s74, 4096
    s_mov_b32 s75, 0x20000
    s_add_u32 s76, s46, s94
    s_addc_u32 s77, s47, 0
    s_mov_b32 s78, 4096
    s_mov_b32 s79, 0x20000
    v_lshlrev_b32 v253, 1, v249
    s_lshl_b32 s94, s68, 1
    buffer_load_ushort v216, v253, s[72:75], s94 offen
    buffer_load_ushort v217, v253, s[76:79], s94 offen
    s_lshl_b32 s94, s99, 12
    s_add_u32 s80, s50, s94
    s_addc_u32 s81, s51, 0
    s_mov_b32 s82, 4096
    s_mov_b32 s83, 0x20000
    s_add_u32 s84, s52, s94
    s_addc_u32 s85, s53, 0
    s_mov_b32 s86, 4096
    s_mov_b32 s87, 0x20000
    v_lshlrev_b32 v254, 3, v3
    s_branch L_i0_done
L_B_i0:
    s_lshl_b32 s92, s69, 15
    s_lshl_b32 s93, s70, 8
    s_add_u32 s92, s92, s93
    s_add_u32 s93, s92, 16384
    buffer_load_dwordx4 v[16:19], v251, s[60:63], s92 offen offset:0
    buffer_load_dwordx4 v[20:23], v251, s[60:63], s92 offen offset:1024
    buffer_load_dwordx4 v[24:27], v251, s[60:63], s92 offen offset:2048
    buffer_load_dwordx4 v[28:31], v251, s[60:63], s92 offen offset:3072
    buffer_load_dwordx4 v[32:35], v251, s[60:63], s93 offen offset:0
    buffer_load_dwordx4 v[36:39], v251, s[60:63], s93 offen offset:1024
    buffer_load_dwordx4 v[40:43], v251, s[60:63], s93 offen offset:2048
    buffer_load_dwordx4 v[44:47], v251, s[60:63], s93 offen offset:3072
    s_lshl_b32 s94, s99, 12
    s_add_u32 s80, s50, s94
    s_addc_u32 s81, s51, 0
    s_mov_b32 s82, 4096
    s_mov_b32 s83, 0x20000
    s_add_u32 s84, s52, s94
    s_addc_u32 s85, s53, 0
    s_mov_b32 s86, 4096
    s_mov_b32 s87, 0x20000
    v_lshlrev_b32 v254, 3, v3
    s_lshl_b32 s94, s69, 6
    buffer_load_dwordx2 v[216:217], v254, s[80:83], s94 offen offset:0
    buffer_load_dwordx2 v[220:221], v254, s[84:87], s94 offen offset:0
    buffer_load_dwordx2 v[218:219], v254, s[80:83], s94 offen offset:32
    buffer_load_dwordx2 v[222:223], v254, s[84:87], s94 offen offset:32
    s_lshl_b32 s94, s99, 12
    s_add_u32 s72, s44, s94
    s_addc_u32 s73, s45, 0
    s_mov_b32 s74, 4096
    s_mov_b32 s75, 0x20000
    s_add_u32 s76, s46, s94
    s_addc_u32 s77, s47, 0
    s_mov_b32 s78, 4096
    s_mov_b32 s79, 0x20000
    v_lshlrev_b32 v253, 1, v249
L_i0_done:
    s_mov_b32 s41, 4096
    buffer_load_dwordx4 v[96:99], v14, s[12:15], 0 offen offset:0
    buffer_load_dwordx4 v[100:103], v14, s[12:15], 0 offen offset:256
    buffer_load_dwordx4 v[104:107], v14, s[12:15], 0 offen offset:2048
    buffer_load_dwordx4 v[108:111], v14, s[12:15], 0 offen offset:2304
    buffer_load_dwordx4 v[112:115], v14, s[12:15], s41 offen offset:0
    buffer_load_dwordx4 v[116:119], v14, s[12:15], s41 offen offset:256
    buffer_load_dwordx4 v[120:123], v14, s[12:15], s41 offen offset:2048
    buffer_load_dwordx4 v[124:127], v14, s[12:15], s41 offen offset:2304
    s_mov_b32 s40, s68
    s_mov_b32 s41, s69
    s_mov_b32 s42, s70
    s_and_b32 s92, s33, 1
    s_lshl_b32 s93, s90, 1
    s_add_u32 s92, s92, s93
    s_lshl_b32 s43, s92, 3
    s_add_u32 s43, s43, 512
    s_lshr_b32 s44, s92, 2
    s_add_u32 s44, s44, 16
    s_and_b32 s45, s92, 3
    s_and_b32 s92, s33, 1
    s_lshl_b32 s93, s90, 1
    s_add_u32 s92, s92, s93
    s_lshl_b32 s68, s92, 3
    s_add_u32 s68, s68, 1024
    s_lshr_b32 s69, s92, 2
    s_add_u32 s69, s69, 32
    s_and_b32 s70, s92, 3
    s_and_b32 s92, s33, 1
    s_lshl_b32 s93, s90, 1
    s_add_u32 s92, s92, s93
    s_lshl_b32 s46, s92, 3
    s_add_u32 s46, s46, 1536
    s_lshr_b32 s47, s92, 2
    s_add_u32 s47, s47, 48
    s_and_b32 s48, s92, 3
    v_mov_b32 v139, 0
    s_cmp_ge_u32 s33, 2
    s_cbranch_scc1 L_B_sc
    s_lshl_b32 s94, s44, 6
    buffer_load_dwordx2 v[224:225], v254, s[80:83], s94 offen offset:0
    buffer_load_dwordx2 v[228:229], v254, s[84:87], s94 offen offset:0
    buffer_load_dwordx2 v[226:227], v254, s[80:83], s94 offen offset:32
    buffer_load_dwordx2 v[230:231], v254, s[84:87], s94 offen offset:32
    s_lshl_b32 s94, s68, 1
    buffer_load_ushort v232, v253, s[72:75], s94 offen
    buffer_load_ushort v233, v253, s[76:79], s94 offen
    s_lshl_b32 s94, s47, 6
    buffer_load_dwordx2 v[240:241], v254, s[80:83], s94 offen offset:0
    buffer_load_dwordx2 v[244:245], v254, s[84:87], s94 offen offset:0
    buffer_load_dwordx2 v[242:243], v254, s[80:83], s94 offen offset:32
    buffer_load_dwordx2 v[246:247], v254, s[84:87], s94 offen offset:32
    s_branch L_sc_done
L_B_sc:
    s_lshl_b32 s94, s43, 1
    buffer_load_ushort v224, v253, s[72:75], s94 offen
    buffer_load_ushort v225, v253, s[76:79], s94 offen
    s_lshl_b32 s94, s69, 6
    buffer_load_dwordx2 v[232:233], v254, s[80:83], s94 offen offset:0
    buffer_load_dwordx2 v[236:237], v254, s[84:87], s94 offen offset:0
    buffer_load_dwordx2 v[234:235], v254, s[80:83], s94 offen offset:32
    buffer_load_dwordx2 v[238:239], v254, s[84:87], s94 offen offset:32
    s_lshl_b32 s94, s46, 1
    buffer_load_ushort v240, v253, s[72:75], s94 offen
    buffer_load_ushort v241, v253, s[76:79], s94 offen
L_sc_done:
    s_mov_b32 s88, s64
    s_mov_b32 s89, s65
    s_or_b32 s92, s99, s90
    s_or_b32 s92, s92, s33
    s_cmp_lg_u32 s92, 0
    s_cbranch_scc1 L_nononce
    s_memrealtime s[100:101]
    s_waitcnt lgkmcnt(0)
    s_lshl_b32 s100, s100, 3
    s_or_b32 s100, s100, 0x80000000
    s_and_b32 s100, s100, 0xfffffff8
    v_mov_b32 v140, s100
    s_mov_b64 exec, 1
    global_store_dword v139, v140, s[88:89] sc1
    s_mov_b64 exec, -1
L_nononce:
    global_load_dword v138, v139, s[88:89] sc1
    s_cmp_ge_u32 s33, 2
    s_cbranch_scc1 L_B_i1
    s_lshl_b32 s92, s44, 15
    s_lshl_b32 s93, s45, 8
    s_add_u32 s92, s92, s93
    s_add_u32 s93, s92, 16384
    buffer_load_dwordx4 v[48:51], v251, s[60:63], s92 offen offset:0
    buffer_load_dwordx4 v[52:55], v251, s[60:63], s92 offen offset:1024
    buffer_load_dwordx4 v[56:59], v251, s[60:63], s92 offen offset:2048
    buffer_load_dwordx4 v[60:63], v251, s[60:63], s92 offen offset:3072
    buffer_load_dwordx4 v[64:67], v251, s[60:63], s93 offen offset:0
    buffer_load_dwordx4 v[68:71], v251, s[60:63], s93 offen offset:1024
    buffer_load_dwordx4 v[72:75], v251, s[60:63], s93 offen offset:2048
    buffer_load_dwordx4 v[76:79], v251, s[60:63], s93 offen offset:3072
    s_branch L_i1_done
L_B_i1:
    s_lshl_b32 s92, s43, 10
    buffer_load_dwordx4 v[48:51], v248, s[56:59], s92 offen offset:0
    buffer_load_dwordx4 v[52:55], v248, s[56:59], s92 offen offset:16
    buffer_load_dwordx4 v[56:59], v248, s[56:59], s92 offen offset:256
    buffer_load_dwordx4 v[60:63], v248, s[56:59], s92 offen offset:272
    buffer_load_dwordx4 v[64:67], v248, s[56:59], s92 offen offset:512
    buffer_load_dwordx4 v[68:71], v248, s[56:59], s92 offen offset:528
    buffer_load_dwordx4 v[72:75], v248, s[56:59], s92 offen offset:768
    buffer_load_dwordx4 v[76:79], v248, s[56:59], s92 offen offset:784
L_i1_done:
    s_mov_b32 s34, 0xffff0000
    s_mov_b32 s32, 0x3db8aa3b
    s_and_b32 s31, s90, 3
    s_lshl_b32 s92, s99, 20
    s_add_u32 s4, s66, s92
    s_addc_u32 s5, s67, 0
    s_mov_b32 s6, 1048576
    s_mov_b32 s7, 0x20000
    s_add_u32 s93, s92, 0x800000
    s_add_u32 s8, s66, s93
    s_addc_u32 s9, s67, 0
    s_mov_b32 s10, 1048576
    s_mov_b32 s11, 0x20000
    s_add_u32 s50, s66, 0x1000000
    s_addc_u32 s51, s67, 0
    s_lshl_b32 s92, s90, 6
    v_add_u32 v136, s92, v4
    v_cvt_f32_u32 v136, v136
    v_and_b32 v160, 7, v0
    v_lshlrev_b32 v160, 3, v160
    v_cvt_f32_u32 v160, v160
    v_lshlrev_b32 v161, 3, v2
    v_cvt_f32_u32 v161, v161
    s_mov_b32 s92, 0xbdd49a78
    v_mov_b32 v200, 0xc029b21d
    v_mov_b32 v201, 0xc03056f1
    v_mov_b32 v202, 0xc036fbc4
    v_mov_b32 v203, 0xc03da098
    v_mov_b32 v204, 0xc044456c
    v_mov_b32 v205, 0xc04aea40
    v_mov_b32 v206, 0xc0518f13
    v_mov_b32 v207, 0xc05833e7
    v_mov_b32 v208, 0xc114b9c3
    v_mov_b32 v209, 0xc11662f8
    v_mov_b32 v210, 0xc1180c2d
    v_mov_b32 v211, 0xc119b562
    v_mov_b32 v212, 0xc11b5e97
    v_mov_b32 v213, 0xc11d07cc
    v_mov_b32 v214, 0xc11eb101
    v_mov_b32 v215, 0xc1205a36
    v_fma_f32 v200, v160, s92, v200
    v_fma_f32 v201, v160, s92, v201
    v_fma_f32 v202, v160, s92, v202
    v_fma_f32 v203, v160, s92, v203
    v_fma_f32 v204, v160, s92, v204
    v_fma_f32 v205, v160, s92, v205
    v_fma_f32 v206, v160, s92, v206
    v_fma_f32 v207, v160, s92, v207
    v_fma_f32 v208, v160, s92, v208
    v_fma_f32 v209, v160, s92, v209
    v_fma_f32 v210, v160, s92, v210
    v_fma_f32 v211, v160, s92, v211
    v_fma_f32 v212, v160, s92, v212
    v_fma_f32 v213, v160, s92, v213
    v_fma_f32 v214, v160, s92, v214
    v_fma_f32 v215, v160, s92, v215
    v_exp_f32 v200, v200
    v_exp_f32 v201, v201
    v_exp_f32 v202, v202
    v_exp_f32 v203, v203
    v_exp_f32 v204, v204
    v_exp_f32 v205, v205
    v_exp_f32 v206, v206
    v_exp_f32 v207, v207
    v_exp_f32 v208, v208
    v_exp_f32 v209, v209
    v_exp_f32 v210, v210
    v_exp_f32 v211, v211
    v_exp_f32 v212, v212
    v_exp_f32 v213, v213
    v_exp_f32 v214, v214
    v_exp_f32 v215, v215
    s_nop 0
    s_mov_b32 s92, 0xbdd49a78
    v_mov_b32 v128, 0xc029b21d
    v_mov_b32 v129, 0xc03056f1
    v_mov_b32 v130, 0xc036fbc4
    v_mov_b32 v131, 0xc03da098
    v_mov_b32 v132, 0xc044456c
    v_mov_b32 v133, 0xc04aea40
    v_mov_b32 v134, 0xc0518f13
    v_mov_b32 v135, 0xc05833e7
    v_fma_f32 v128, v161, s92, v128
    v_fma_f32 v129, v161, s92, v129
    v_fma_f32 v130, v161, s92, v130
    v_fma_f32 v131, v161, s92, v131
    v_fma_f32 v132, v161, s92, v132
    v_fma_f32 v133, v161, s92, v133
    v_fma_f32 v134, v161, s92, v134
    v_fma_f32 v135, v161, s92, v135
    v_exp_f32 v128, v128
    v_exp_f32 v129, v129
    v_exp_f32 v130, v130
    v_exp_f32 v131, v131
    v_exp_f32 v132, v132
    v_exp_f32 v133, v133
    v_exp_f32 v134, v134
    v_exp_f32 v135, v135
    s_nop 0
    v_mul_u32_u24 v8, 8704, v1
    v_lshrrev_b32 v160, 2, v2
    v_mul_u32_u24 v160, 1088, v160
    v_add_u32 v8, v8, v160
    v_and_b32 v160, 3, v2
    v_mul_u32_u24 v160, 272, v160
    v_add_u32 v8, v8, v160
    v_lshl_add_u32 v8, v3, 4, v8
    v_mul_u32_u24 v9, 272, v3
    v_lshl_add_u32 v9, v2, 4, v9
    v_accvgpr_write_b32 a0, 0
    v_accvgpr_write_b32 a1, 0
    v_accvgpr_write_b32 a2, 0
    v_accvgpr_write_b32 a3, 0
    v_accvgpr_write_b32 a4, 0
    v_accvgpr_write_b32 a5, 0
    v_accvgpr_write_b32 a6, 0
    v_accvgpr_write_b32 a7, 0
    v_accvgpr_write_b32 a8, 0
    v_accvgpr_write_b32 a9, 0
    v_accvgpr_write_b32 a10, 0
    v_accvgpr_write_b32 a11, 0
    v_accvgpr_write_b32 a12, 0
    v_accvgpr_write_b32 a13, 0
    v_accvgpr_write_b32 a14, 0
    v_accvgpr_write_b32 a15, 0
    v_accvgpr_write_b32 a16, 0
    v_accvgpr_write_b32 a17, 0
    v_accvgpr_write_b32 a18, 0
    v_accvgpr_write_b32 a19, 0
    v_accvgpr_write_b32 a20, 0
    v_accvgpr_write_b32 a21, 0
    v_accvgpr_write_b32 a22, 0
    v_accvgpr_write_b32 a23, 0
    v_accvgpr_write_b32 a24, 0
    v_accvgpr_write_b32 a25, 0
    v_accvgpr_write_b32 a26, 0
    v_accvgpr_write_b32 a27, 0
    v_accvgpr_write_b32 a28, 0
    v_accvgpr_write_b32 a29, 0
    v_accvgpr_write_b32 a30, 0
    v_accvgpr_write_b32 a31, 0
    v_accvgpr_write_b32 a32, 0
    v_accvgpr_write_b32 a33, 0
    v_accvgpr_write_b32 a34, 0
    v_accvgpr_write_b32 a35, 0
    v_accvgpr_write_b32 a36, 0
    v_accvgpr_write_b32 a37, 0
    v_accvgpr_write_b32 a38, 0
    v_accvgpr_write_b32 a39, 0
    v_accvgpr_write_b32 a40, 0
    v_accvgpr_write_b32 a41, 0
    v_accvgpr_write_b32 a42, 0
    v_accvgpr_write_b32 a43, 0
    v_accvgpr_write_b32 a44, 0
    v_accvgpr_write_b32 a45, 0
    v_accvgpr_write_b32 a46, 0
    v_accvgpr_write_b32 a47, 0
    v_accvgpr_write_b32 a48, 0
    v_accvgpr_write_b32 a49, 0
    v_accvgpr_write_b32 a50, 0
    v_accvgpr_write_b32 a51, 0
    v_accvgpr_write_b32 a52, 0
    v_accvgpr_write_b32 a53, 0
    v_accvgpr_write_b32 a54, 0
    v_accvgpr_write_b32 a55, 0
    v_accvgpr_write_b32 a56, 0
    v_accvgpr_write_b32 a57, 0
    v_accvgpr_write_b32 a58, 0
    v_accvgpr_write_b32 a59, 0
    v_accvgpr_write_b32 a60, 0
    v_accvgpr_write_b32 a61, 0
    v_accvgpr_write_b32 a62, 0
    v_accvgpr_write_b32 a63, 0
    s_waitcnt vmcnt(25)
    s_cmp_ge_u32 s33, 2
    s_cbranch_scc1 L_B_c0
    v_lshlrev_b32 v216, 16, v216
    v_lshlrev_b32 v217, 16, v217
    v_cvt_f32_u32 v160, v249
    v_cvt_f32_u32 v161, s40
    v_mul_f32 v217, v217, v216
    v_add_f32 v160, v160, v161
    v_cvt_f32_i32 v16, v16
    v_cvt_f32_i32 v17, v17
    v_cvt_f32_i32 v18, v18
    v_cvt_f32_i32 v19, v19
    v_cvt_f32_i32 v20, v20
    v_cvt_f32_i32 v21, v21
    v_cvt_f32_i32 v22, v22
    v_cvt_f32_i32 v23, v23
    v_cvt_f32_i32 v24, v24
    v_cvt_f32_i32 v25, v25
    v_cvt_f32_i32 v26, v26
    v_cvt_f32_i32 v27, v27
    v_cvt_f32_i32 v28, v28
    v_cvt_f32_i32 v29, v29
    v_cvt_f32_i32 v30, v30
    v_cvt_f32_i32 v31, v31
    v_cvt_f32_i32 v32, v32
    v_cvt_f32_i32 v33, v33
    v_cvt_f32_i32 v34, v34
    v_cvt_f32_i32 v35, v35
    v_cvt_f32_i32 v36, v36
    v_cvt_f32_i32 v37, v37
    v_cvt_f32_i32 v38, v38
    v_cvt_f32_i32 v39, v39
    v_cvt_f32_i32 v40, v40
    v_cvt_f32_i32 v41, v41
    v_cvt_f32_i32 v42, v42
    v_cvt_f32_i32 v43, v43
    v_cvt_f32_i32 v44, v44
    v_cvt_f32_i32 v45, v45
    v_cvt_f32_i32 v46, v46
    v_cvt_f32_i32 v47, v47
    v_pk_mul_f32 v[170:171], v[200:201], v[160:161] op_sel_hi:[1,0]
    v_pk_mul_f32 v[172:173], v[202:203], v[160:161] op_sel_hi:[1,0]
    v_pk_mul_f32 v[174:175], v[204:205], v[160:161] op_sel_hi:[1,0]
    v_pk_mul_f32 v[176:177], v[206:207], v[160:161] op_sel_hi:[1,0]
    v_fract_f32 v170, v170
    v_fract_f32 v171, v171
    v_fract_f32 v172, v172
    v_fract_f32 v173, v173
    v_fract_f32 v174, v174
    v_fract_f32 v175, v175
    v_fract_f32 v176, v176
    v_fract_f32 v177, v177
    v_cos_f32 v162, v170
    v_cos_f32 v163, v171
    v_cos_f32 v164, v172
    v_cos_f32 v165, v173
    v_cos_f32 v166, v174
    v_cos_f32 v167, v175
    v_cos_f32 v168, v176
    v_cos_f32 v169, v177
    v_sin_f32 v170, v170
    v_sin_f32 v171, v171
    v_sin_f32 v172, v172
    v_sin_f32 v173, v173
    v_sin_f32 v174, v174
    v_sin_f32 v175, v175
    v_sin_f32 v176, v176
    v_sin_f32 v177, v177
    v_pk_fma_f32 v[16:17], v[16:17], v[216:217], v[216:217] op_sel:[0,0,1] op_sel_hi:[1,0,1] neg_lo:[0,0,1] neg_hi:[0,0,1]
    v_pk_fma_f32 v[18:19], v[18:19], v[216:217], v[216:217] op_sel:[0,0,1] op_sel_hi:[1,0,1] neg_lo:[0,0,1] neg_hi:[0,0,1]
    v_pk_fma_f32 v[20:21], v[20:21], v[216:217], v[216:217] op_sel:[0,0,1] op_sel_hi:[1,0,1] neg_lo:[0,0,1] neg_hi:[0,0,1]
    v_pk_fma_f32 v[22:23], v[22:23], v[216:217], v[216:217] op_sel:[0,0,1] op_sel_hi:[1,0,1] neg_lo:[0,0,1] neg_hi:[0,0,1]
    v_pk_fma_f32 v[24:25], v[24:25], v[216:217], v[216:217] op_sel:[0,0,1] op_sel_hi:[1,0,1] neg_lo:[0,0,1] neg_hi:[0,0,1]
    v_pk_fma_f32 v[26:27], v[26:27], v[216:217], v[216:217] op_sel:[0,0,1] op_sel_hi:[1,0,1] neg_lo:[0,0,1] neg_hi:[0,0,1]
    v_pk_fma_f32 v[28:29], v[28:29], v[216:217], v[216:217] op_sel:[0,0,1] op_sel_hi:[1,0,1] neg_lo:[0,0,1] neg_hi:[0,0,1]
    v_pk_fma_f32 v[30:31], v[30:31], v[216:217], v[216:217] op_sel:[0,0,1] op_sel_hi:[1,0,1] neg_lo:[0,0,1] neg_hi:[0,0,1]
    v_pk_fma_f32 v[32:33], v[32:33], v[216:217], v[216:217] op_sel:[0,0,1] op_sel_hi:[1,0,1] neg_lo:[0,0,1] neg_hi:[0,0,1]
    v_pk_fma_f32 v[34:35], v[34:35], v[216:217], v[216:217] op_sel:[0,0,1] op_sel_hi:[1,0,1] neg_lo:[0,0,1] neg_hi:[0,0,1]
    v_pk_fma_f32 v[36:37], v[36:37], v[216:217], v[216:217] op_sel:[0,0,1] op_sel_hi:[1,0,1] neg_lo:[0,0,1] neg_hi:[0,0,1]
    v_pk_fma_f32 v[38:39], v[38:39], v[216:217], v[216:217] op_sel:[0,0,1] op_sel_hi:[1,0,1] neg_lo:[0,0,1] neg_hi:[0,0,1]
    v_pk_fma_f32 v[40:41], v[40:41], v[216:217], v[216:217] op_sel:[0,0,1] op_sel_hi:[1,0,1] neg_lo:[0,0,1] neg_hi:[0,0,1]
    v_pk_fma_f32 v[42:43], v[42:43], v[216:217], v[216:217] op_sel:[0,0,1] op_sel_hi:[1,0,1] neg_lo:[0,0,1] neg_hi:[0,0,1]
    v_pk_fma_f32 v[44:45], v[44:45], v[216:217], v[216:217] op_sel:[0,0,1] op_sel_hi:[1,0,1] neg_lo:[0,0,1] neg_hi:[0,0,1]
    v_pk_fma_f32 v[46:47], v[46:47], v[216:217], v[216:217] op_sel:[0,0,1] op_sel_hi:[1,0,1] neg_lo:[0,0,1] neg_hi:[0,0,1]
    v_pk_mul_f32 v[178:179], v[32:33], v[170:171]
    v_pk_mul_f32 v[180:181], v[34:35], v[172:173]
    v_pk_mul_f32 v[182:183], v[36:37], v[174:175]
    v_pk_mul_f32 v[184:185], v[38:39], v[176:177]
    v_pk_mul_f32 v[170:171], v[16:17], v[170:171]
    v_pk_mul_f32 v[172:173], v[18:19], v[172:173]
    v_pk_mul_f32 v[174:175], v[20:21], v[174:175]
    v_pk_mul_f32 v[176:177], v[22:23], v[176:177]
    v_pk_fma_f32 v[178:179], v[16:17], v[162:163], v[178:179] neg_lo:[0,0,1] neg_hi:[0,0,1]
    v_pk_fma_f32 v[180:181], v[18:19], v[164:165], v[180:181] neg_lo:[0,0,1] neg_hi:[0,0,1]
    v_pk_fma_f32 v[182:183], v[20:21], v[166:167], v[182:183] neg_lo:[0,0,1] neg_hi:[0,0,1]
    v_pk_fma_f32 v[184:185], v[22:23], v[168:169], v[184:185] neg_lo:[0,0,1] neg_hi:[0,0,1]
    v_pk_fma_f32 v[170:171], v[32:33], v[162:163], v[170:171]
    v_pk_fma_f32 v[172:173], v[34:35], v[164:165], v[172:173]
    v_pk_fma_f32 v[174:175], v[36:37], v[166:167], v[174:175]
    v_pk_fma_f32 v[176:177], v[38:39], v[168:169], v[176:177]
    v_cvt_pk_bf16_f32 v16, v178, v179
    v_cvt_pk_bf16_f32 v17, v180, v181
    v_cvt_pk_bf16_f32 v18, v182, v183
    v_cvt_pk_bf16_f32 v19, v184, v185
    v_cvt_pk_bf16_f32 v32, v170, v171
    v_cvt_pk_bf16_f32 v33, v172, v173
    v_cvt_pk_bf16_f32 v34, v174, v175
    v_cvt_pk_bf16_f32 v35, v176, v177
    v_pk_mul_f32 v[170:171], v[208:209], v[160:161] op_sel_hi:[1,0]
    v_pk_mul_f32 v[172:173], v[210:211], v[160:161] op_sel_hi:[1,0]
    v_pk_mul_f32 v[174:175], v[212:213], v[160:161] op_sel_hi:[1,0]
    v_pk_mul_f32 v[176:177], v[214:215], v[160:161] op_sel_hi:[1,0]
    v_fract_f32 v170, v170
    v_fract_f32 v171, v171
    v_fract_f32 v172, v172
    v_fract_f32 v173, v173
    v_fract_f32 v174, v174
    v_fract_f32 v175, v175
    v_fract_f32 v176, v176
    v_fract_f32 v177, v177
    v_cos_f32 v162, v170
    v_cos_f32 v163, v171
    v_cos_f32 v164, v172
    v_cos_f32 v165, v173
    v_cos_f32 v166, v174
    v_cos_f32 v167, v175
    v_cos_f32 v168, v176
    v_cos_f32 v169, v177
    v_sin_f32 v170, v170
    v_sin_f32 v171, v171
    v_sin_f32 v172, v172
    v_sin_f32 v173, v173
    v_sin_f32 v174, v174
    v_sin_f32 v175, v175
    v_sin_f32 v176, v176
    v_sin_f32 v177, v177
    s_nop 0
    v_pk_mul_f32 v[178:179], v[40:41], v[170:171]
    v_pk_mul_f32 v[180:181], v[42:43], v[172:173]
    v_pk_mul_f32 v[182:183], v[44:45], v[174:175]
    v_pk_mul_f32 v[184:185], v[46:47], v[176:177]
    v_pk_mul_f32 v[170:171], v[24:25], v[170:171]
    v_pk_mul_f32 v[172:173], v[26:27], v[172:173]
    v_pk_mul_f32 v[174:175], v[28:29], v[174:175]
    v_pk_mul_f32 v[176:177], v[30:31], v[176:177]
    v_pk_fma_f32 v[178:179], v[24:25], v[162:163], v[178:179] neg_lo:[0,0,1] neg_hi:[0,0,1]
    v_pk_fma_f32 v[180:181], v[26:27], v[164:165], v[180:181] neg_lo:[0,0,1] neg_hi:[0,0,1]
    v_pk_fma_f32 v[182:183], v[28:29], v[166:167], v[182:183] neg_lo:[0,0,1] neg_hi:[0,0,1]
    v_pk_fma_f32 v[184:185], v[30:31], v[168:169], v[184:185] neg_lo:[0,0,1] neg_hi:[0,0,1]
    v_pk_fma_f32 v[170:171], v[40:41], v[162:163], v[170:171]
    v_pk_fma_f32 v[172:173], v[42:43], v[164:165], v[172:173]
    v_pk_fma_f32 v[174:175], v[44:45], v[166:167], v[174:175]
    v_pk_fma_f32 v[176:177], v[46:47], v[168:169], v[176:177]
    v_cvt_pk_bf16_f32 v24, v178, v179
    v_cvt_pk_bf16_f32 v25, v180, v181
    v_cvt_pk_bf16_f32 v26, v182, v183
    v_cvt_pk_bf16_f32 v27, v184, v185
    v_cvt_pk_bf16_f32 v40, v170, v171
    v_cvt_pk_bf16_f32 v41, v172, v173
    v_cvt_pk_bf16_f32 v42, v174, v175
    v_cvt_pk_bf16_f32 v43, v176, v177
    s_lshr_b32 s92, s40, 4
    s_lshl_b32 s92, s92, 13
    s_and_b32 s93, s40, 8
    s_lshl_b32 s93, s93, 4
    s_add_u32 s92, s92, s93
    s_add_u32 s93, s92, 4096
    buffer_store_dwordx4 v[16:19], v250, s[4:7], s92 offen offset:0 sc1
    buffer_store_dwordx4 v[24:27], v250, s[4:7], s92 offen offset:2048 sc1
    buffer_store_dwordx4 v[32:35], v250, s[4:7], s93 offen offset:0 sc1
    buffer_store_dwordx4 v[40:43], v250, s[4:7], s93 offen offset:2048 sc1
    s_branch L_c0_done
L_B_c0:
    v_lshlrev_b32 v160, 16, v216
    v_lshlrev_b32 v161, 16, v220
    v_and_b32 v162, s34, v216
    v_and_b32 v163, s34, v220
    v_lshlrev_b32 v164, 16, v217
    v_lshlrev_b32 v165, 16, v221
    v_and_b32 v166, s34, v217
    v_and_b32 v167, s34, v221
    v_lshlrev_b32 v168, 16, v218
    v_lshlrev_b32 v169, 16, v222
    v_and_b32 v170, s34, v218
    v_and_b32 v171, s34, v222
    v_lshlrev_b32 v172, 16, v219
    v_lshlrev_b32 v173, 16, v223
    v_and_b32 v174, s34, v219
    v_and_b32 v175, s34, v223
    v_cvt_f32_i32 v16, v16
    v_cvt_f32_i32 v17, v17
    v_cvt_f32_i32 v18, v18
    v_cvt_f32_i32 v19, v19
    v_cvt_f32_i32 v20, v20
    v_cvt_f32_i32 v21, v21
    v_cvt_f32_i32 v22, v22
    v_cvt_f32_i32 v23, v23
    v_cvt_f32_i32 v24, v24
    v_cvt_f32_i32 v25, v25
    v_cvt_f32_i32 v26, v26
    v_cvt_f32_i32 v27, v27
    v_cvt_f32_i32 v28, v28
    v_cvt_f32_i32 v29, v29
    v_cvt_f32_i32 v30, v30
    v_cvt_f32_i32 v31, v31
    v_cvt_f32_i32 v32, v32
    v_cvt_f32_i32 v33, v33
    v_cvt_f32_i32 v34, v34
    v_cvt_f32_i32 v35, v35
    v_cvt_f32_i32 v36, v36
    v_cvt_f32_i32 v37, v37
    v_cvt_f32_i32 v38, v38
    v_cvt_f32_i32 v39, v39
    v_cvt_f32_i32 v40, v40
    v_cvt_f32_i32 v41, v41
    v_cvt_f32_i32 v42, v42
    v_cvt_f32_i32 v43, v43
    v_cvt_f32_i32 v44, v44
    v_cvt_f32_i32 v45, v45
    v_cvt_f32_i32 v46, v46
    v_cvt_f32_i32 v47, v47
    v_mul_f32 v161, v161, v160
    v_mul_f32 v163, v163, v162
    v_mul_f32 v165, v165, v164
    v_mul_f32 v167, v167, v166
    v_mul_f32 v169, v169, v168
    v_mul_f32 v171, v171, v170
    v_mul_f32 v173, v173, v172
    v_mul_f32 v175, v175, v174
    v_pk_fma_f32 v[16:17], v[16:17], v[160:161], v[160:161] op_sel:[0,0,1] op_sel_hi:[1,0,1] neg_lo:[0,0,1] neg_hi:[0,0,1]
    v_pk_fma_f32 v[18:19], v[18:19], v[160:161], v[160:161] op_sel:[0,0,1] op_sel_hi:[1,0,1] neg_lo:[0,0,1] neg_hi:[0,0,1]
    v_pk_fma_f32 v[20:21], v[20:21], v[162:163], v[162:163] op_sel:[0,0,1] op_sel_hi:[1,0,1] neg_lo:[0,0,1] neg_hi:[0,0,1]
    v_pk_fma_f32 v[22:23], v[22:23], v[162:163], v[162:163] op_sel:[0,0,1] op_sel_hi:[1,0,1] neg_lo:[0,0,1] neg_hi:[0,0,1]
    v_pk_fma_f32 v[24:25], v[24:25], v[164:165], v[164:165] op_sel:[0,0,1] op_sel_hi:[1,0,1] neg_lo:[0,0,1] neg_hi:[0,0,1]
    v_pk_fma_f32 v[26:27], v[26:27], v[164:165], v[164:165] op_sel:[0,0,1] op_sel_hi:[1,0,1] neg_lo:[0,0,1] neg_hi:[0,0,1]
    v_pk_fma_f32 v[28:29], v[28:29], v[166:167], v[166:167] op_sel:[0,0,1] op_sel_hi:[1,0,1] neg_lo:[0,0,1] neg_hi:[0,0,1]
    v_pk_fma_f32 v[30:31], v[30:31], v[166:167], v[166:167] op_sel:[0,0,1] op_sel_hi:[1,0,1] neg_lo:[0,0,1] neg_hi:[0,0,1]
    v_pk_fma_f32 v[32:33], v[32:33], v[168:169], v[168:169] op_sel:[0,0,1] op_sel_hi:[1,0,1] neg_lo:[0,0,1] neg_hi:[0,0,1]
    v_pk_fma_f32 v[34:35], v[34:35], v[168:169], v[168:169] op_sel:[0,0,1] op_sel_hi:[1,0,1] neg_lo:[0,0,1] neg_hi:[0,0,1]
    v_pk_fma_f32 v[36:37], v[36:37], v[170:171], v[170:171] op_sel:[0,0,1] op_sel_hi:[1,0,1] neg_lo:[0,0,1] neg_hi:[0,0,1]
    v_pk_fma_f32 v[38:39], v[38:39], v[170:171], v[170:171] op_sel:[0,0,1] op_sel_hi:[1,0,1] neg_lo:[0,0,1] neg_hi:[0,0,1]
    v_pk_fma_f32 v[40:41], v[40:41], v[172:173], v[172:173] op_sel:[0,0,1] op_sel_hi:[1,0,1] neg_lo:[0,0,1] neg_hi:[0,0,1]
    v_pk_fma_f32 v[42:43], v[42:43], v[172:173], v[172:173] op_sel:[0,0,1] op_sel_hi:[1,0,1] neg_lo:[0,0,1] neg_hi:[0,0,1]
    v_pk_fma_f32 v[44:45], v[44:45], v[174:175], v[174:175] op_sel:[0,0,1] op_sel_hi:[1,0,1] neg_lo:[0,0,1] neg_hi:[0,0,1]
    v_pk_fma_f32 v[46:47], v[46:47], v[174:175], v[174:175] op_sel:[0,0,1] op_sel_hi:[1,0,1] neg_lo:[0,0,1] neg_hi:[0,0,1]
    v_cvt_pk_bf16_f32 v160, v16, v20
    v_cvt_pk_bf16_f32 v161, v24, v28
    v_cvt_pk_bf16_f32 v162, v32, v36
    v_cvt_pk_bf16_f32 v163, v40, v44
    v_cvt_pk_bf16_f32 v164, v17, v21
    v_cvt_pk_bf16_f32 v165, v25, v29
    v_cvt_pk_bf16_f32 v166, v33, v37
    v_cvt_pk_bf16_f32 v167, v41, v45
    v_cvt_pk_bf16_f32 v168, v18, v22
    v_cvt_pk_bf16_f32 v169, v26, v30
    v_cvt_pk_bf16_f32 v170, v34, v38
    v_cvt_pk_bf16_f32 v171, v42, v46
    v_cvt_pk_bf16_f32 v172, v19, v23
    v_cvt_pk_bf16_f32 v173, v27, v31
    v_cvt_pk_bf16_f32 v174, v35, v39
    v_cvt_pk_bf16_f32 v175, v43, v47
    s_lshr_b32 s92, s41, 2
    s_lshl_b32 s92, s92, 16
    s_lshl_b32 s93, s42, 14
    s_add_u32 s92, s92, s93
    s_sub_u32 s93, s41, s42
    s_and_b32 s93, s93, 3
    s_lshl_b32 s93, s93, 10
    s_add_u32 s92, s92, s93
    buffer_store_dwordx4 v[160:163], v252, s[8:11], s92 offen sc1
    s_add_u32 s92, s92, 4096
    buffer_store_dwordx4 v[164:167], v252, s[8:11], s92 offen sc1
    s_add_u32 s92, s92, 4096
    buffer_store_dwordx4 v[168:171], v252, s[8:11], s92 offen sc1
    s_add_u32 s92, s92, 4096
    buffer_store_dwordx4 v[172:175], v252, s[8:11], s92 offen sc1
L_c0_done:
    s_cmp_ge_u32 s33, 2
    s_cbranch_scc1 L_B_i2
    s_lshl_b32 s92, s68, 10
    buffer_load_dwordx4 v[16:19], v248, s[56:59], s92 offen offset:0
    buffer_load_dwordx4 v[20:23], v248, s[56:59], s92 offen offset:16
    buffer_load_dwordx4 v[24:27], v248, s[56:59], s92 offen offset:256
    buffer_load_dwordx4 v[28:31], v248, s[56:59], s92 offen offset:272
    buffer_load_dwordx4 v[32:35], v248, s[56:59], s92 offen offset:512
    buffer_load_dwordx4 v[36:39], v248, s[56:59], s92 offen offset:528
    buffer_load_dwordx4 v[40:43], v248, s[56:59], s92 offen offset:768
    buffer_load_dwordx4 v[44:47], v248, s[56:59], s92 offen offset:784
    s_branch L_i2_done
L_B_i2:
    s_lshl_b32 s92, s69, 15
    s_lshl_b32 s93, s70, 8
    s_add_u32 s92, s92, s93
    s_add_u32 s93, s92, 16384
    buffer_load_dwordx4 v[16:19], v251, s[60:63], s92 offen offset:0
    buffer_load_dwordx4 v[20:23], v251, s[60:63], s92 offen offset:1024
    buffer_load_dwordx4 v[24:27], v251, s[60:63], s92 offen offset:2048
    buffer_load_dwordx4 v[28:31], v251, s[60:63], s92 offen offset:3072
    buffer_load_dwordx4 v[32:35], v251, s[60:63], s93 offen offset:0
    buffer_load_dwordx4 v[36:39], v251, s[60:63], s93 offen offset:1024
    buffer_load_dwordx4 v[40:43], v251, s[60:63], s93 offen offset:2048
    buffer_load_dwordx4 v[44:47], v251, s[60:63], s93 offen offset:3072
L_i2_done:
    s_waitcnt vmcnt(20)
    v_pk_mul_f32 v[184:185], v[128:129], v[136:137] op_sel_hi:[1,0]
    v_pk_mul_f32 v[186:187], v[130:131], v[136:137] op_sel_hi:[1,0]
    v_pk_mul_f32 v[188:189], v[132:133], v[136:137] op_sel_hi:[1,0]
    v_pk_mul_f32 v[190:191], v[134:135], v[136:137] op_sel_hi:[1,0]
    v_fract_f32 v184, v184
    v_fract_f32 v185, v185
    v_fract_f32 v186, v186
    v_fract_f32 v187, v187
    v_fract_f32 v188, v188
    v_fract_f32 v189, v189
    v_fract_f32 v190, v190
    v_fract_f32 v191, v191
    v_cos_f32 v176, v184
    v_cos_f32 v177, v185
    v_cos_f32 v178, v186
    v_cos_f32 v179, v187
    v_cos_f32 v180, v188
    v_cos_f32 v181, v189
    v_cos_f32 v182, v190
    v_cos_f32 v183, v191
    v_sin_f32 v184, v184
    v_sin_f32 v185, v185
    v_sin_f32 v186, v186
    v_sin_f32 v187, v187
    v_sin_f32 v188, v188
    v_sin_f32 v189, v189
    v_sin_f32 v190, v190
    v_sin_f32 v191, v191
    v_lshlrev_b32 v160, 16, v96
    v_and_b32 v161, s34, v96
    v_lshlrev_b32 v168, 16, v100
    v_and_b32 v169, s34, v100
    v_lshlrev_b32 v162, 16, v97
    v_and_b32 v163, s34, v97
    v_lshlrev_b32 v170, 16, v101
    v_and_b32 v171, s34, v101
    v_lshlrev_b32 v164, 16, v98
    v_and_b32 v165, s34, v98
    v_lshlrev_b32 v172, 16, v102
    v_and_b32 v173, s34, v102
    v_lshlrev_b32 v166, 16, v99
    v_and_b32 v167, s34, v99
    v_lshlrev_b32 v174, 16, v103
    v_and_b32 v175, s34, v103
    v_pk_mul_f32 v[176:177], v[176:177], s[32:33] op_sel_hi:[1,0]
    v_pk_mul_f32 v[178:179], v[178:179], s[32:33] op_sel_hi:[1,0]
    v_pk_mul_f32 v[180:181], v[180:181], s[32:33] op_sel_hi:[1,0]
    v_pk_mul_f32 v[182:183], v[182:183], s[32:33] op_sel_hi:[1,0]
    v_pk_mul_f32 v[184:185], v[184:185], s[32:33] op_sel_hi:[1,0]
    v_pk_mul_f32 v[186:187], v[186:187], s[32:33] op_sel_hi:[1,0]
    v_pk_mul_f32 v[188:189], v[188:189], s[32:33] op_sel_hi:[1,0]
    v_pk_mul_f32 v[190:191], v[190:191], s[32:33] op_sel_hi:[1,0]
    v_pk_mul_f32 v[192:193], v[168:169], v[184:185]
    v_pk_mul_f32 v[194:195], v[170:171], v[186:187]
    v_pk_mul_f32 v[196:197], v[172:173], v[188:189]
    v_pk_mul_f32 v[198:199], v[174:175], v[190:191]
    v_pk_mul_f32 v[184:185], v[160:161], v[184:185]
    v_pk_mul_f32 v[186:187], v[162:163], v[186:187]
    v_pk_mul_f32 v[188:189], v[164:165], v[188:189]
    v_pk_mul_f32 v[190:191], v[166:167], v[190:191]
    v_pk_fma_f32 v[192:193], v[160:161], v[176:177], v[192:193] neg_lo:[0,0,1] neg_hi:[0,0,1]
    v_pk_fma_f32 v[194:195], v[162:163], v[178:179], v[194:195] neg_lo:[0,0,1] neg_hi:[0,0,1]
    v_pk_fma_f32 v[196:197], v[164:165], v[180:181], v[196:197] neg_lo:[0,0,1] neg_hi:[0,0,1]
    v_pk_fma_f32 v[198:199], v[166:167], v[182:183], v[198:199] neg_lo:[0,0,1] neg_hi:[0,0,1]
    v_pk_fma_f32 v[184:185], v[168:169], v[176:177], v[184:185]
    v_pk_fma_f32 v[186:187], v[170:171], v[178:179], v[186:187]
    v_pk_fma_f32 v[188:189], v[172:173], v[180:181], v[188:189]
    v_pk_fma_f32 v[190:191], v[174:175], v[182:183], v[190:191]
    v_cvt_pk_bf16_f32 v160, v192, v193
    v_cvt_pk_bf16_f32 v161, v194, v195
    v_cvt_pk_bf16_f32 v162, v196, v197
    v_cvt_pk_bf16_f32 v163, v198, v199
    v_cvt_pk_bf16_f32 v164, v184, v185
    v_cvt_pk_bf16_f32 v165, v186, v187
    v_cvt_pk_bf16_f32 v166, v188, v189
    v_cvt_pk_bf16_f32 v167, v190, v191
    ds_write_b128 v8, v[160:163] offset:0
    ds_write_b128 v8, v[164:167] offset:4352
    v_add_f32 v136, 4.0, v136
    v_pk_mul_f32 v[184:185], v[128:129], v[136:137] op_sel_hi:[1,0]
    v_pk_mul_f32 v[186:187], v[130:131], v[136:137] op_sel_hi:[1,0]
    v_pk_mul_f32 v[188:189], v[132:133], v[136:137] op_sel_hi:[1,0]
    v_pk_mul_f32 v[190:191], v[134:135], v[136:137] op_sel_hi:[1,0]
    v_fract_f32 v184, v184
    v_fract_f32 v185, v185
    v_fract_f32 v186, v186
    v_fract_f32 v187, v187
    v_fract_f32 v188, v188
    v_fract_f32 v189, v189
    v_fract_f32 v190, v190
    v_fract_f32 v191, v191
    v_cos_f32 v176, v184
    v_cos_f32 v177, v185
    v_cos_f32 v178, v186
    v_cos_f32 v179, v187
    v_cos_f32 v180, v188
    v_cos_f32 v181, v189
    v_cos_f32 v182, v190
    v_cos_f32 v183, v191
    v_sin_f32 v184, v184
    v_sin_f32 v185, v185
    v_sin_f32 v186, v186
    v_sin_f32 v187, v187
    v_sin_f32 v188, v188
    v_sin_f32 v189, v189
    v_sin_f32 v190, v190
    v_sin_f32 v191, v191
    v_lshlrev_b32 v160, 16, v104
    v_and_b32 v161, s34, v104
    v_lshlrev_b32 v168, 16, v108
    v_and_b32 v169, s34, v108
    v_lshlrev_b32 v162, 16, v105
    v_and_b32 v163, s34, v105
    v_lshlrev_b32 v170, 16, v109
    v_and_b32 v171, s34, v109
    v_lshlrev_b32 v164, 16, v106
    v_and_b32 v165, s34, v106
    v_lshlrev_b32 v172, 16, v110
    v_and_b32 v173, s34, v110
    v_lshlrev_b32 v166, 16, v107
    v_and_b32 v167, s34, v107
    v_lshlrev_b32 v174, 16, v111
    v_and_b32 v175, s34, v111
    v_pk_mul_f32 v[176:177], v[176:177], s[32:33] op_sel_hi:[1,0]
    v_pk_mul_f32 v[178:179], v[178:179], s[32:33] op_sel_hi:[1,0]
    v_pk_mul_f32 v[180:181], v[180:181], s[32:33] op_sel_hi:[1,0]
    v_pk_mul_f32 v[182:183], v[182:183], s[32:33] op_sel_hi:[1,0]
    v_pk_mul_f32 v[184:185], v[184:185], s[32:33] op_sel_hi:[1,0]
    v_pk_mul_f32 v[186:187], v[186:187], s[32:33] op_sel_hi:[1,0]
    v_pk_mul_f32 v[188:189], v[188:189], s[32:33] op_sel_hi:[1,0]
    v_pk_mul_f32 v[190:191], v[190:191], s[32:33] op_sel_hi:[1,0]
    v_pk_mul_f32 v[192:193], v[168:169], v[184:185]
    v_pk_mul_f32 v[194:195], v[170:171], v[186:187]
    v_pk_mul_f32 v[196:197], v[172:173], v[188:189]
    v_pk_mul_f32 v[198:199], v[174:175], v[190:191]
    v_pk_mul_f32 v[184:185], v[160:161], v[184:185]
    v_pk_mul_f32 v[186:187], v[162:163], v[186:187]
    v_pk_mul_f32 v[188:189], v[164:165], v[188:189]
    v_pk_mul_f32 v[190:191], v[166:167], v[190:191]
    v_pk_fma_f32 v[192:193], v[160:161], v[176:177], v[192:193] neg_lo:[0,0,1] neg_hi:[0,0,1]
    v_pk_fma_f32 v[194:195], v[162:163], v[178:179], v[194:195] neg_lo:[0,0,1] neg_hi:[0,0,1]
    v_pk_fma_f32 v[196:197], v[164:165], v[180:181], v[196:197] neg_lo:[0,0,1] neg_hi:[0,0,1]
    v_pk_fma_f32 v[198:199], v[166:167], v[182:183], v[198:199] neg_lo:[0,0,1] neg_hi:[0,0,1]
    v_pk_fma_f32 v[184:185], v[168:169], v[176:177], v[184:185]
    v_pk_fma_f32 v[186:187], v[170:171], v[178:179], v[186:187]
    v_pk_fma_f32 v[188:189], v[172:173], v[180:181], v[188:189]
    v_pk_fma_f32 v[190:191], v[174:175], v[182:183], v[190:191]
    v_cvt_pk_bf16_f32 v160, v192, v193
    v_cvt_pk_bf16_f32 v161, v194, v195
    v_cvt_pk_bf16_f32 v162, v196, v197
    v_cvt_pk_bf16_f32 v163, v198, v199
    v_cvt_pk_bf16_f32 v164, v184, v185
    v_cvt_pk_bf16_f32 v165, v186, v187
    v_cvt_pk_bf16_f32 v166, v188, v189
    v_cvt_pk_bf16_f32 v167, v190, v191
    ds_write_b128 v8, v[160:163] offset:64
    ds_write_b128 v8, v[164:167] offset:4416
    v_add_f32 v136, 4.0, v136
    v_pk_mul_f32 v[184:185], v[128:129], v[136:137] op_sel_hi:[1,0]
    v_pk_mul_f32 v[186:187], v[130:131], v[136:137] op_sel_hi:[1,0]
    v_pk_mul_f32 v[188:189], v[132:133], v[136:137] op_sel_hi:[1,0]
    v_pk_mul_f32 v[190:191], v[134:135], v[136:137] op_sel_hi:[1,0]
    v_fract_f32 v184, v184
    v_fract_f32 v185, v185
    v_fract_f32 v186, v186
    v_fract_f32 v187, v187
    v_fract_f32 v188, v188
    v_fract_f32 v189, v189
    v_fract_f32 v190, v190
    v_fract_f32 v191, v191
    v_cos_f32 v176, v184
    v_cos_f32 v177, v185
    v_cos_f32 v178, v186
    v_cos_f32 v179, v187
    v_cos_f32 v180, v188
    v_cos_f32 v181, v189
    v_cos_f32 v182, v190
    v_cos_f32 v183, v191
    v_sin_f32 v184, v184
    v_sin_f32 v185, v185
    v_sin_f32 v186, v186
    v_sin_f32 v187, v187
    v_sin_f32 v188, v188
    v_sin_f32 v189, v189
    v_sin_f32 v190, v190
    v_sin_f32 v191, v191
    v_lshlrev_b32 v160, 16, v112
    v_and_b32 v161, s34, v112
    v_lshlrev_b32 v168, 16, v116
    v_and_b32 v169, s34, v116
    v_lshlrev_b32 v162, 16, v113
    v_and_b32 v163, s34, v113
    v_lshlrev_b32 v170, 16, v117
    v_and_b32 v171, s34, v117
    v_lshlrev_b32 v164, 16, v114
    v_and_b32 v165, s34, v114
    v_lshlrev_b32 v172, 16, v118
    v_and_b32 v173, s34, v118
    v_lshlrev_b32 v166, 16, v115
    v_and_b32 v167, s34, v115
    v_lshlrev_b32 v174, 16, v119
    v_and_b32 v175, s34, v119
    v_pk_mul_f32 v[176:177], v[176:177], s[32:33] op_sel_hi:[1,0]
    v_pk_mul_f32 v[178:179], v[178:179], s[32:33] op_sel_hi:[1,0]
    v_pk_mul_f32 v[180:181], v[180:181], s[32:33] op_sel_hi:[1,0]
    v_pk_mul_f32 v[182:183], v[182:183], s[32:33] op_sel_hi:[1,0]
    v_pk_mul_f32 v[184:185], v[184:185], s[32:33] op_sel_hi:[1,0]
    v_pk_mul_f32 v[186:187], v[186:187], s[32:33] op_sel_hi:[1,0]
    v_pk_mul_f32 v[188:189], v[188:189], s[32:33] op_sel_hi:[1,0]
    v_pk_mul_f32 v[190:191], v[190:191], s[32:33] op_sel_hi:[1,0]
    v_pk_mul_f32 v[192:193], v[168:169], v[184:185]
    v_pk_mul_f32 v[194:195], v[170:171], v[186:187]
    v_pk_mul_f32 v[196:197], v[172:173], v[188:189]
    v_pk_mul_f32 v[198:199], v[174:175], v[190:191]
    v_pk_mul_f32 v[184:185], v[160:161], v[184:185]
    v_pk_mul_f32 v[186:187], v[162:163], v[186:187]
    v_pk_mul_f32 v[188:189], v[164:165], v[188:189]
    v_pk_mul_f32 v[190:191], v[166:167], v[190:191]
    v_pk_fma_f32 v[192:193], v[160:161], v[176:177], v[192:193] neg_lo:[0,0,1] neg_hi:[0,0,1]
    v_pk_fma_f32 v[194:195], v[162:163], v[178:179], v[194:195] neg_lo:[0,0,1] neg_hi:[0,0,1]
    v_pk_fma_f32 v[196:197], v[164:165], v[180:181], v[196:197] neg_lo:[0,0,1] neg_hi:[0,0,1]
    v_pk_fma_f32 v[198:199], v[166:167], v[182:183], v[198:199] neg_lo:[0,0,1] neg_hi:[0,0,1]
    v_pk_fma_f32 v[184:185], v[168:169], v[176:177], v[184:185]
    v_pk_fma_f32 v[186:187], v[170:171], v[178:179], v[186:187]
    v_pk_fma_f32 v[188:189], v[172:173], v[180:181], v[188:189]
    v_pk_fma_f32 v[190:191], v[174:175], v[182:183], v[190:191]
    v_cvt_pk_bf16_f32 v160, v192, v193
    v_cvt_pk_bf16_f32 v161, v194, v195
    v_cvt_pk_bf16_f32 v162, v196, v197
    v_cvt_pk_bf16_f32 v163, v198, v199
    v_cvt_pk_bf16_f32 v164, v184, v185
    v_cvt_pk_bf16_f32 v165, v186, v187
    v_cvt_pk_bf16_f32 v166, v188, v189
    v_cvt_pk_bf16_f32 v167, v190, v191
    ds_write_b128 v8, v[160:163] offset:128
    ds_write_b128 v8, v[164:167] offset:4480
    v_add_f32 v136, 4.0, v136
    v_pk_mul_f32 v[184:185], v[128:129], v[136:137] op_sel_hi:[1,0]
    v_pk_mul_f32 v[186:187], v[130:131], v[136:137] op_sel_hi:[1,0]
    v_pk_mul_f32 v[188:189], v[132:133], v[136:137] op_sel_hi:[1,0]
    v_pk_mul_f32 v[190:191], v[134:135], v[136:137] op_sel_hi:[1,0]
    v_fract_f32 v184, v184
    v_fract_f32 v185, v185
    v_fract_f32 v186, v186
    v_fract_f32 v187, v187
    v_fract_f32 v188, v188
    v_fract_f32 v189, v189
    v_fract_f32 v190, v190
    v_fract_f32 v191, v191
    v_cos_f32 v176, v184
    v_cos_f32 v177, v185
    v_cos_f32 v178, v186
    v_cos_f32 v179, v187
    v_cos_f32 v180, v188
    v_cos_f32 v181, v189
    v_cos_f32 v182, v190
    v_cos_f32 v183, v191
    v_sin_f32 v184, v184
    v_sin_f32 v185, v185
    v_sin_f32 v186, v186
    v_sin_f32 v187, v187
    v_sin_f32 v188, v188
    v_sin_f32 v189, v189
    v_sin_f32 v190, v190
    v_sin_f32 v191, v191
    v_lshlrev_b32 v160, 16, v120
    v_and_b32 v161, s34, v120
    v_lshlrev_b32 v168, 16, v124
    v_and_b32 v169, s34, v124
    v_lshlrev_b32 v162, 16, v121
    v_and_b32 v163, s34, v121
    v_lshlrev_b32 v170, 16, v125
    v_and_b32 v171, s34, v125
    v_lshlrev_b32 v164, 16, v122
    v_and_b32 v165, s34, v122
    v_lshlrev_b32 v172, 16, v126
    v_and_b32 v173, s34, v126
    v_lshlrev_b32 v166, 16, v123
    v_and_b32 v167, s34, v123
    v_lshlrev_b32 v174, 16, v127
    v_and_b32 v175, s34, v127
    v_pk_mul_f32 v[176:177], v[176:177], s[32:33] op_sel_hi:[1,0]
    v_pk_mul_f32 v[178:179], v[178:179], s[32:33] op_sel_hi:[1,0]
    v_pk_mul_f32 v[180:181], v[180:181], s[32:33] op_sel_hi:[1,0]
    v_pk_mul_f32 v[182:183], v[182:183], s[32:33] op_sel_hi:[1,0]
    v_pk_mul_f32 v[184:185], v[184:185], s[32:33] op_sel_hi:[1,0]
    v_pk_mul_f32 v[186:187], v[186:187], s[32:33] op_sel_hi:[1,0]
    v_pk_mul_f32 v[188:189], v[188:189], s[32:33] op_sel_hi:[1,0]
    v_pk_mul_f32 v[190:191], v[190:191], s[32:33] op_sel_hi:[1,0]
    v_pk_mul_f32 v[192:193], v[168:169], v[184:185]
    v_pk_mul_f32 v[194:195], v[170:171], v[186:187]
    v_pk_mul_f32 v[196:197], v[172:173], v[188:189]
    v_pk_mul_f32 v[198:199], v[174:175], v[190:191]
    v_pk_mul_f32 v[184:185], v[160:161], v[184:185]
    v_pk_mul_f32 v[186:187], v[162:163], v[186:187]
    v_pk_mul_f32 v[188:189], v[164:165], v[188:189]
    v_pk_mul_f32 v[190:191], v[166:167], v[190:191]
    v_pk_fma_f32 v[192:193], v[160:161], v[176:177], v[192:193] neg_lo:[0,0,1] neg_hi:[0,0,1]
    v_pk_fma_f32 v[194:195], v[162:163], v[178:179], v[194:195] neg_lo:[0,0,1] neg_hi:[0,0,1]
    v_pk_fma_f32 v[196:197], v[164:165], v[180:181], v[196:197] neg_lo:[0,0,1] neg_hi:[0,0,1]
    v_pk_fma_f32 v[198:199], v[166:167], v[182:183], v[198:199] neg_lo:[0,0,1] neg_hi:[0,0,1]
    v_pk_fma_f32 v[184:185], v[168:169], v[176:177], v[184:185]
    v_pk_fma_f32 v[186:187], v[170:171], v[178:179], v[186:187]
    v_pk_fma_f32 v[188:189], v[172:173], v[180:181], v[188:189]
    v_pk_fma_f32 v[190:191], v[174:175], v[182:183], v[190:191]
    v_cvt_pk_bf16_f32 v160, v192, v193
    v_cvt_pk_bf16_f32 v161, v194, v195
    v_cvt_pk_bf16_f32 v162, v196, v197
    v_cvt_pk_bf16_f32 v163, v198, v199
    v_cvt_pk_bf16_f32 v164, v184, v185
    v_cvt_pk_bf16_f32 v165, v186, v187
    v_cvt_pk_bf16_f32 v166, v188, v189
    v_cvt_pk_bf16_f32 v167, v190, v191
    ds_write_b128 v8, v[160:163] offset:192
    ds_write_b128 v8, v[164:167] offset:4544
    s_waitcnt vmcnt(8)
    v_readfirstlane_b32 s39, v138
    s_cmp_lg_u32 s39, 0
    s_cbranch_scc1 L_have_nonce
    s_mov_b32 s97, 0
L_nonce_spin:
    global_load_dword v138, v139, s[88:89] sc1
    s_waitcnt vmcnt(0)
    v_readfirstlane_b32 s39, v138
    s_add_u32 s97, s97, 1
    s_cmp_ge_u32 s97, 0x8000
    s_cbranch_scc1 L_have_nonce
    s_cmp_eq_u32 s39, 0
    s_cbranch_scc1 L_nonce_spin
L_have_nonce:
    s_waitcnt lgkmcnt(0)
    s_barrier
    s_cmp_lg_u32 s33, 0
    s_cbranch_scc1 L_pub1
    s_mov_b64 exec, 1
    s_add_u32 s93, s39, 1
    v_mov_b32 v140, s93
    s_lshl_b32 s92, s99, 5
    s_add_u32 s92, s92, s90
    s_lshl_b32 s92, s92, 7
    v_mov_b32 v141, s92
    global_store_dword v141, v140, s[50:51] sc1
    s_mov_b64 exec, -1
L_pub1:
    ds_read_b128 a[64:67], v9 offset:0
    ds_read_b128 a[68:71], v9 offset:1088
    ds_read_b128 a[72:75], v9 offset:2176
    ds_read_b128 a[76:79], v9 offset:3264
    ds_read_b128 a[80:83], v9 offset:4352
    ds_read_b128 a[84:87], v9 offset:5440
    ds_read_b128 a[88:91], v9 offset:6528
    ds_read_b128 a[92:95], v9 offset:7616
    ds_read_b128 a[96:99], v9 offset:8704
    ds_read_b128 a[100:103], v9 offset:9792
    ds_read_b128 a[104:107], v9 offset:10880
    ds_read_b128 a[108:111], v9 offset:11968
    ds_read_b128 a[112:115], v9 offset:13056
    ds_read_b128 a[116:119], v9 offset:14144
    ds_read_b128 a[120:123], v9 offset:15232
    ds_read_b128 a[124:127], v9 offset:16320
    ds_read_b128 a[128:131], v9 offset:17408
    ds_read_b128 a[132:135], v9 offset:18496
    ds_read_b128 a[136:139], v9 offset:19584
    ds_read_b128 a[140:143], v9 offset:20672
    ds_read_b128 a[144:147], v9 offset:21760
    ds_read_b128 a[148:151], v9 offset:22848
    ds_read_b128 a[152:155], v9 offset:23936
    ds_read_b128 a[156:159], v9 offset:25024
    ds_read_b128 a[160:163], v9 offset:26112
    ds_read_b128 a[164:167], v9 offset:27200
    ds_read_b128 a[168:171], v9 offset:28288
    ds_read_b128 a[172:175], v9 offset:29376
    ds_read_b128 a[176:179], v9 offset:30464
    ds_read_b128 a[180:183], v9 offset:31552
    ds_read_b128 a[184:187], v9 offset:32640
    ds_read_b128 a[188:191], v9 offset:33728
    s_waitcnt vmcnt(8)
    s_cmp_ge_u32 s33, 2
    s_cbranch_scc1 L_B_c1
    v_lshlrev_b32 v160, 16, v224
    v_lshlrev_b32 v161, 16, v228
    v_and_b32 v162, s34, v224
    v_and_b32 v163, s34, v228
    v_lshlrev_b32 v164, 16, v225
    v_lshlrev_b32 v165, 16, v229
    v_and_b32 v166, s34, v225
    v_and_b32 v167, s34, v229
    v_lshlrev_b32 v168, 16, v226
    v_lshlrev_b32 v169, 16, v230
    v_and_b32 v170, s34, v226
    v_and_b32 v171, s34, v230
    v_lshlrev_b32 v172, 16, v227
    v_lshlrev_b32 v173, 16, v231
    v_and_b32 v174, s34, v227
    v_and_b32 v175, s34, v231
    v_cvt_f32_i32 v48, v48
    v_cvt_f32_i32 v49, v49
    v_cvt_f32_i32 v50, v50
    v_cvt_f32_i32 v51, v51
    v_cvt_f32_i32 v52, v52
    v_cvt_f32_i32 v53, v53
    v_cvt_f32_i32 v54, v54
    v_cvt_f32_i32 v55, v55
    v_cvt_f32_i32 v56, v56
    v_cvt_f32_i32 v57, v57
    v_cvt_f32_i32 v58, v58
    v_cvt_f32_i32 v59, v59
    v_cvt_f32_i32 v60, v60
    v_cvt_f32_i32 v61, v61
    v_cvt_f32_i32 v62, v62
    v_cvt_f32_i32 v63, v63
    v_cvt_f32_i32 v64, v64
    v_cvt_f32_i32 v65, v65
    v_cvt_f32_i32 v66, v66
    v_cvt_f32_i32 v67, v67
    v_cvt_f32_i32 v68, v68
    v_cvt_f32_i32 v69, v69
    v_cvt_f32_i32 v70, v70
    v_cvt_f32_i32 v71, v71
    v_cvt_f32_i32 v72, v72
    v_cvt_f32_i32 v73, v73
    v_cvt_f32_i32 v74, v74
    v_cvt_f32_i32 v75, v75
    v_cvt_f32_i32 v76, v76
    v_cvt_f32_i32 v77, v77
    v_cvt_f32_i32 v78, v78
    v_cvt_f32_i32 v79, v79
    v_mul_f32 v161, v161, v160
    v_mul_f32 v163, v163, v162
    v_mul_f32 v165, v165, v164
    v_mul_f32 v167, v167, v166
    v_mul_f32 v169, v169, v168
    v_mul_f32 v171, v171, v170
    v_mul_f32 v173, v173, v172
    v_mul_f32 v175, v175, v174
    v_pk_fma_f32 v[48:49], v[48:49], v[160:161], v[160:161] op_sel:[0,0,1] op_sel_hi:[1,0,1] neg_lo:[0,0,1] neg_hi:[0,0,1]
    v_pk_fma_f32 v[50:51], v[50:51], v[160:161], v[160:161] op_sel:[0,0,1] op_sel_hi:[1,0,1] neg_lo:[0,0,1] neg_hi:[0,0,1]
    v_pk_fma_f32 v[52:53], v[52:53], v[162:163], v[162:163] op_sel:[0,0,1] op_sel_hi:[1,0,1] neg_lo:[0,0,1] neg_hi:[0,0,1]
    v_pk_fma_f32 v[54:55], v[54:55], v[162:163], v[162:163] op_sel:[0,0,1] op_sel_hi:[1,0,1] neg_lo:[0,0,1] neg_hi:[0,0,1]
    v_pk_fma_f32 v[56:57], v[56:57], v[164:165], v[164:165] op_sel:[0,0,1] op_sel_hi:[1,0,1] neg_lo:[0,0,1] neg_hi:[0,0,1]
    v_pk_fma_f32 v[58:59], v[58:59], v[164:165], v[164:165] op_sel:[0,0,1] op_sel_hi:[1,0,1] neg_lo:[0,0,1] neg_hi:[0,0,1]
    v_pk_fma_f32 v[60:61], v[60:61], v[166:167], v[166:167] op_sel:[0,0,1] op_sel_hi:[1,0,1] neg_lo:[0,0,1] neg_hi:[0,0,1]
    v_pk_fma_f32 v[62:63], v[62:63], v[166:167], v[166:167] op_sel:[0,0,1] op_sel_hi:[1,0,1] neg_lo:[0,0,1] neg_hi:[0,0,1]
    v_pk_fma_f32 v[64:65], v[64:65], v[168:169], v[168:169] op_sel:[0,0,1] op_sel_hi:[1,0,1] neg_lo:[0,0,1] neg_hi:[0,0,1]
    v_pk_fma_f32 v[66:67], v[66:67], v[168:169], v[168:169] op_sel:[0,0,1] op_sel_hi:[1,0,1] neg_lo:[0,0,1] neg_hi:[0,0,1]
    v_pk_fma_f32 v[68:69], v[68:69], v[170:171], v[170:171] op_sel:[0,0,1] op_sel_hi:[1,0,1] neg_lo:[0,0,1] neg_hi:[0,0,1]
    v_pk_fma_f32 v[70:71], v[70:71], v[170:171], v[170:171] op_sel:[0,0,1] op_sel_hi:[1,0,1] neg_lo:[0,0,1] neg_hi:[0,0,1]
    v_pk_fma_f32 v[72:73], v[72:73], v[172:173], v[172:173] op_sel:[0,0,1] op_sel_hi:[1,0,1] neg_lo:[0,0,1] neg_hi:[0,0,1]
    v_pk_fma_f32 v[74:75], v[74:75], v[172:173], v[172:173] op_sel:[0,0,1] op_sel_hi:[1,0,1] neg_lo:[0,0,1] neg_hi:[0,0,1]
    v_pk_fma_f32 v[76:77], v[76:77], v[174:175], v[174:175] op_sel:[0,0,1] op_sel_hi:[1,0,1] neg_lo:[0,0,1] neg_hi:[0,0,1]
    v_pk_fma_f32 v[78:79], v[78:79], v[174:175], v[174:175] op_sel:[0,0,1] op_sel_hi:[1,0,1] neg_lo:[0,0,1] neg_hi:[0,0,1]
    v_cvt_pk_bf16_f32 v160, v48, v52
    v_cvt_pk_bf16_f32 v161, v56, v60
    v_cvt_pk_bf16_f32 v162, v64, v68
    v_cvt_pk_bf16_f32 v163, v72, v76
    v_cvt_pk_bf16_f32 v164, v49, v53
    v_cvt_pk_bf16_f32 v165, v57, v61
    v_cvt_pk_bf16_f32 v166, v65, v69
    v_cvt_pk_bf16_f32 v167, v73, v77
    v_cvt_pk_bf16_f32 v168, v50, v54
    v_cvt_pk_bf16_f32 v169, v58, v62
    v_cvt_pk_bf16_f32 v170, v66, v70
    v_cvt_pk_bf16_f32 v171, v74, v78
    v_cvt_pk_bf16_f32 v172, v51, v55
    v_cvt_pk_bf16_f32 v173, v59, v63
    v_cvt_pk_bf16_f32 v174, v67, v71
    v_cvt_pk_bf16_f32 v175, v75, v79
    s_lshr_b32 s92, s44, 2
    s_lshl_b32 s92, s92, 16
    s_lshl_b32 s93, s45, 14
    s_add_u32 s92, s92, s93
    s_sub_u32 s93, s44, s45
    s_and_b32 s93, s93, 3
    s_lshl_b32 s93, s93, 10
    s_add_u32 s92, s92, s93
    buffer_store_dwordx4 v[160:163], v252, s[8:11], s92 offen sc1
    s_add_u32 s92, s92, 4096
    buffer_store_dwordx4 v[164:167], v252, s[8:11], s92 offen sc1
    s_add_u32 s92, s92, 4096
    buffer_store_dwordx4 v[168:171], v252, s[8:11], s92 offen sc1
    s_add_u32 s92, s92, 4096
    buffer_store_dwordx4 v[172:175], v252, s[8:11], s92 offen sc1
    s_branch L_c1_done
L_B_c1:
    v_lshlrev_b32 v224, 16, v224
    v_lshlrev_b32 v225, 16, v225
    v_cvt_f32_u32 v160, v249
    v_cvt_f32_u32 v161, s43
    v_mul_f32 v225, v225, v224
    v_add_f32 v160, v160, v161
    v_cvt_f32_i32 v48, v48
    v_cvt_f32_i32 v49, v49
    v_cvt_f32_i32 v50, v50
    v_cvt_f32_i32 v51, v51
    v_cvt_f32_i32 v52, v52
    v_cvt_f32_i32 v53, v53
    v_cvt_f32_i32 v54, v54
    v_cvt_f32_i32 v55, v55
    v_cvt_f32_i32 v56, v56
    v_cvt_f32_i32 v57, v57
    v_cvt_f32_i32 v58, v58
    v_cvt_f32_i32 v59, v59
    v_cvt_f32_i32 v60, v60
    v_cvt_f32_i32 v61, v61
    v_cvt_f32_i32 v62, v62
    v_cvt_f32_i32 v63, v63
    v_cvt_f32_i32 v64, v64
    v_cvt_f32_i32 v65, v65
    v_cvt_f32_i32 v66, v66
    v_cvt_f32_i32 v67, v67
    v_cvt_f32_i32 v68, v68
    v_cvt_f32_i32 v69, v69
    v_cvt_f32_i32 v70, v70
    v_cvt_f32_i32 v71, v71
    v_cvt_f32_i32 v72, v72
    v_cvt_f32_i32 v73, v73
    v_cvt_f32_i32 v74, v74
    v_cvt_f32_i32 v75, v75
    v_cvt_f32_i32 v76, v76
    v_cvt_f32_i32 v77, v77
    v_cvt_f32_i32 v78, v78
    v_cvt_f32_i32 v79, v79
    v_pk_mul_f32 v[170:171], v[200:201], v[160:161] op_sel_hi:[1,0]
    v_pk_mul_f32 v[172:173], v[202:203], v[160:161] op_sel_hi:[1,0]
    v_pk_mul_f32 v[174:175], v[204:205], v[160:161] op_sel_hi:[1,0]
    v_pk_mul_f32 v[176:177], v[206:207], v[160:161] op_sel_hi:[1,0]
    v_fract_f32 v170, v170
    v_fract_f32 v171, v171
    v_fract_f32 v172, v172
    v_fract_f32 v173, v173
    v_fract_f32 v174, v174
    v_fract_f32 v175, v175
    v_fract_f32 v176, v176
    v_fract_f32 v177, v177
    v_cos_f32 v162, v170
    v_cos_f32 v163, v171
    v_cos_f32 v164, v172
    v_cos_f32 v165, v173
    v_cos_f32 v166, v174
    v_cos_f32 v167, v175
    v_cos_f32 v168, v176
    v_cos_f32 v169, v177
    v_sin_f32 v170, v170
    v_sin_f32 v171, v171
    v_sin_f32 v172, v172
    v_sin_f32 v173, v173
    v_sin_f32 v174, v174
    v_sin_f32 v175, v175
    v_sin_f32 v176, v176
    v_sin_f32 v177, v177
    v_pk_fma_f32 v[48:49], v[48:49], v[224:225], v[224:225] op_sel:[0,0,1] op_sel_hi:[1,0,1] neg_lo:[0,0,1] neg_hi:[0,0,1]
    v_pk_fma_f32 v[50:51], v[50:51], v[224:225], v[224:225] op_sel:[0,0,1] op_sel_hi:[1,0,1] neg_lo:[0,0,1] neg_hi:[0,0,1]
    v_pk_fma_f32 v[52:53], v[52:53], v[224:225], v[224:225] op_sel:[0,0,1] op_sel_hi:[1,0,1] neg_lo:[0,0,1] neg_hi:[0,0,1]
    v_pk_fma_f32 v[54:55], v[54:55], v[224:225], v[224:225] op_sel:[0,0,1] op_sel_hi:[1,0,1] neg_lo:[0,0,1] neg_hi:[0,0,1]
    v_pk_fma_f32 v[56:57], v[56:57], v[224:225], v[224:225] op_sel:[0,0,1] op_sel_hi:[1,0,1] neg_lo:[0,0,1] neg_hi:[0,0,1]
    v_pk_fma_f32 v[58:59], v[58:59], v[224:225], v[224:225] op_sel:[0,0,1] op_sel_hi:[1,0,1] neg_lo:[0,0,1] neg_hi:[0,0,1]
    v_pk_fma_f32 v[60:61], v[60:61], v[224:225], v[224:225] op_sel:[0,0,1] op_sel_hi:[1,0,1] neg_lo:[0,0,1] neg_hi:[0,0,1]
    v_pk_fma_f32 v[62:63], v[62:63], v[224:225], v[224:225] op_sel:[0,0,1] op_sel_hi:[1,0,1] neg_lo:[0,0,1] neg_hi:[0,0,1]
    v_pk_fma_f32 v[64:65], v[64:65], v[224:225], v[224:225] op_sel:[0,0,1] op_sel_hi:[1,0,1] neg_lo:[0,0,1] neg_hi:[0,0,1]
    v_pk_fma_f32 v[66:67], v[66:67], v[224:225], v[224:225] op_sel:[0,0,1] op_sel_hi:[1,0,1] neg_lo:[0,0,1] neg_hi:[0,0,1]
    v_pk_fma_f32 v[68:69], v[68:69], v[224:225], v[224:225] op_sel:[0,0,1] op_sel_hi:[1,0,1] neg_lo:[0,0,1] neg_hi:[0,0,1]
    v_pk_fma_f32 v[70:71], v[70:71], v[224:225], v[224:225] op_sel:[0,0,1] op_sel_hi:[1,0,1] neg_lo:[0,0,1] neg_hi:[0,0,1]
    v_pk_fma_f32 v[72:73], v[72:73], v[224:225], v[224:225] op_sel:[0,0,1] op_sel_hi:[1,0,1] neg_lo:[0,0,1] neg_hi:[0,0,1]
    v_pk_fma_f32 v[74:75], v[74:75], v[224:225], v[224:225] op_sel:[0,0,1] op_sel_hi:[1,0,1] neg_lo:[0,0,1] neg_hi:[0,0,1]
    v_pk_fma_f32 v[76:77], v[76:77], v[224:225], v[224:225] op_sel:[0,0,1] op_sel_hi:[1,0,1] neg_lo:[0,0,1] neg_hi:[0,0,1]
    v_pk_fma_f32 v[78:79], v[78:79], v[224:225], v[224:225] op_sel:[0,0,1] op_sel_hi:[1,0,1] neg_lo:[0,0,1] neg_hi:[0,0,1]
    v_pk_mul_f32 v[178:179], v[64:65], v[170:171]
    v_pk_mul_f32 v[180:181], v[66:67], v[172:173]
    v_pk_mul_f32 v[182:183], v[68:69], v[174:175]
    v_pk_mul_f32 v[184:185], v[70:71], v[176:177]
    v_pk_mul_f32 v[170:171], v[48:49], v[170:171]
    v_pk_mul_f32 v[172:173], v[50:51], v[172:173]
    v_pk_mul_f32 v[174:175], v[52:53], v[174:175]
    v_pk_mul_f32 v[176:177], v[54:55], v[176:177]
    v_pk_fma_f32 v[178:179], v[48:49], v[162:163], v[178:179] neg_lo:[0,0,1] neg_hi:[0,0,1]
    v_pk_fma_f32 v[180:181], v[50:51], v[164:165], v[180:181] neg_lo:[0,0,1] neg_hi:[0,0,1]
    v_pk_fma_f32 v[182:183], v[52:53], v[166:167], v[182:183] neg_lo:[0,0,1] neg_hi:[0,0,1]
    v_pk_fma_f32 v[184:185], v[54:55], v[168:169], v[184:185] neg_lo:[0,0,1] neg_hi:[0,0,1]
    v_pk_fma_f32 v[170:171], v[64:65], v[162:163], v[170:171]
    v_pk_fma_f32 v[172:173], v[66:67], v[164:165], v[172:173]
    v_pk_fma_f32 v[174:175], v[68:69], v[166:167], v[174:175]
    v_pk_fma_f32 v[176:177], v[70:71], v[168:169], v[176:177]
    v_cvt_pk_bf16_f32 v48, v178, v179
    v_cvt_pk_bf16_f32 v49, v180, v181
    v_cvt_pk_bf16_f32 v50, v182, v183
    v_cvt_pk_bf16_f32 v51, v184, v185
    v_cvt_pk_bf16_f32 v64, v170, v171
    v_cvt_pk_bf16_f32 v65, v172, v173
    v_cvt_pk_bf16_f32 v66, v174, v175
    v_cvt_pk_bf16_f32 v67, v176, v177
    v_pk_mul_f32 v[170:171], v[208:209], v[160:161] op_sel_hi:[1,0]
    v_pk_mul_f32 v[172:173], v[210:211], v[160:161] op_sel_hi:[1,0]
    v_pk_mul_f32 v[174:175], v[212:213], v[160:161] op_sel_hi:[1,0]
    v_pk_mul_f32 v[176:177], v[214:215], v[160:161] op_sel_hi:[1,0]
    v_fract_f32 v170, v170
    v_fract_f32 v171, v171
    v_fract_f32 v172, v172
    v_fract_f32 v173, v173
    v_fract_f32 v174, v174
    v_fract_f32 v175, v175
    v_fract_f32 v176, v176
    v_fract_f32 v177, v177
    v_cos_f32 v162, v170
    v_cos_f32 v163, v171
    v_cos_f32 v164, v172
    v_cos_f32 v165, v173
    v_cos_f32 v166, v174
    v_cos_f32 v167, v175
    v_cos_f32 v168, v176
    v_cos_f32 v169, v177
    v_sin_f32 v170, v170
    v_sin_f32 v171, v171
    v_sin_f32 v172, v172
    v_sin_f32 v173, v173
    v_sin_f32 v174, v174
    v_sin_f32 v175, v175
    v_sin_f32 v176, v176
    v_sin_f32 v177, v177
    s_nop 0
    v_pk_mul_f32 v[178:179], v[72:73], v[170:171]
    v_pk_mul_f32 v[180:181], v[74:75], v[172:173]
    v_pk_mul_f32 v[182:183], v[76:77], v[174:175]
    v_pk_mul_f32 v[184:185], v[78:79], v[176:177]
    v_pk_mul_f32 v[170:171], v[56:57], v[170:171]
    v_pk_mul_f32 v[172:173], v[58:59], v[172:173]
    v_pk_mul_f32 v[174:175], v[60:61], v[174:175]
    v_pk_mul_f32 v[176:177], v[62:63], v[176:177]
    v_pk_fma_f32 v[178:179], v[56:57], v[162:163], v[178:179] neg_lo:[0,0,1] neg_hi:[0,0,1]
    v_pk_fma_f32 v[180:181], v[58:59], v[164:165], v[180:181] neg_lo:[0,0,1] neg_hi:[0,0,1]
    v_pk_fma_f32 v[182:183], v[60:61], v[166:167], v[182:183] neg_lo:[0,0,1] neg_hi:[0,0,1]
    v_pk_fma_f32 v[184:185], v[62:63], v[168:169], v[184:185] neg_lo:[0,0,1] neg_hi:[0,0,1]
    v_pk_fma_f32 v[170:171], v[72:73], v[162:163], v[170:171]
    v_pk_fma_f32 v[172:173], v[74:75], v[164:165], v[172:173]
    v_pk_fma_f32 v[174:175], v[76:77], v[166:167], v[174:175]
    v_pk_fma_f32 v[176:177], v[78:79], v[168:169], v[176:177]
    v_cvt_pk_bf16_f32 v56, v178, v179
    v_cvt_pk_bf16_f32 v57, v180, v181
    v_cvt_pk_bf16_f32 v58, v182, v183
    v_cvt_pk_bf16_f32 v59, v184, v185
    v_cvt_pk_bf16_f32 v72, v170, v171
    v_cvt_pk_bf16_f32 v73, v172, v173
    v_cvt_pk_bf16_f32 v74, v174, v175
    v_cvt_pk_bf16_f32 v75, v176, v177
    s_lshr_b32 s92, s43, 4
    s_lshl_b32 s92, s92, 13
    s_and_b32 s93, s43, 8
    s_lshl_b32 s93, s93, 4
    s_add_u32 s92, s92, s93
    s_add_u32 s93, s92, 4096
    buffer_store_dwordx4 v[48:51], v250, s[4:7], s92 offen offset:0 sc1
    buffer_store_dwordx4 v[56:59], v250, s[4:7], s92 offen offset:2048 sc1
    buffer_store_dwordx4 v[64:67], v250, s[4:7], s93 offen offset:0 sc1
    buffer_store_dwordx4 v[72:75], v250, s[4:7], s93 offen offset:2048 sc1
L_c1_done:
    s_waitcnt lgkmcnt(0)
    v_and_b32 v160, 63, v0
    v_lshrrev_b32 v161, 6, v0
    v_and_b32 v14, 31, v0
    s_lshl_b32 s92, s99, 5
    v_add_u32 v14, s92, v14
    v_lshlrev_b32 v14, 7, v14
    global_load_dword v13, v14, s[50:51] sc1
    v_lshlrev_b32 v162, 4, v160
    v_add_u32 v163, 51200, v162
    v_add_u32 v164, 1, v161
    v_and_b32 v164, 3, v164
    v_lshl_add_u32 v6, v164, 12, v163
    v_add_u32 v164, 2, v161
    v_and_b32 v164, 3, v164
    v_lshl_add_u32 v7, v164, 12, v163
    v_add_u32 v164, 3, v161
    v_and_b32 v164, 3, v164
    v_lshl_add_u32 v8, v164, 12, v163
    v_lshl_add_u32 v5, v161, 12, v163
    v_lshl_add_u32 v1, v161, 14, v162
    v_add_u32 v2, 4096, v1
    v_add_u32 v3, 8192, v1
    v_add_u32 v4, 12288, v1
    v_mov_b32 v9, 0
    v_mov_b32 v10, 0
    v_mov_b32 v11, 0
    v_mov_b32 v12, 0
    s_mov_b32 s49, 514
    s_add_u32 s91, s39, 1
    s_mov_b32 s53, 3
    v_lshlrev_b32 v166, 4, v160
    ds_write_b128 v166, v[200:203] offset:46080
    ds_write_b128 v166, v[204:207] offset:47104
    ds_write_b128 v166, v[208:211] offset:48128
    ds_write_b128 v166, v[212:215] offset:49152
    s_mul_i32 s93, s33, 2560
    s_add_u32 s93, s93, 35840
    v_add_u32 v166, s93, v166
    ds_write_b128 v166, v[240:243]
    ds_write_b128 v166, v[244:247] offset:1024
    s_mul_i32 s92, s90, 43
    s_lshr_b32 s92, s92, 8
    s_mul_i32 s92, s92, 6
    s_sub_u32 s64, s90, s92
    s_lshl_b32 s38, 0xe, s64
    s_or_b32 s38, s38, 0x404
    s_waitcnt vmcnt(0)
    v_subrev_u32 v13, s91, v13
    v_cmp_lt_u32 vcc, s53, v13
    s_nop 4
    s_cbranch_vccz L_chk_r0_ok
    s_mov_b32 s97, 0
L_spin_r0:
    global_load_dword v13, v14, s[50:51] sc1
    s_waitcnt vmcnt(0)
    v_subrev_u32 v13, s91, v13
    v_cmp_lt_u32 vcc, s53, v13
    s_add_u32 s97, s97, 1
    s_cmp_lt_u32 s97, 0x8000
    s_cbranch_scc0 L_spin_r0_done
    s_nop 3
    s_cbranch_vccnz L_spin_r0
L_spin_r0_done:
L_chk_r0_ok:
    s_lshl_b32 s28, s31, 16
    s_mov_b32 s29, s28
    s_mov_b32 s35, s28
    s_add_u32 s92, s31, 1
    s_and_b32 s92, s92, 3
    s_lshl_b32 s96, s92, 16
    buffer_load_dwordx4 a[192:195], v1, s[4:7], s35 offen offset:0 sc1
    buffer_load_dwordx4 a[196:199], v1, s[4:7], s35 offen offset:1024 sc1
    buffer_load_dwordx4 a[200:203], v1, s[4:7], s35 offen offset:2048 sc1
    buffer_load_dwordx4 a[204:207], v1, s[4:7], s35 offen offset:3072 sc1
    buffer_load_dwordx4 a[208:211], v2, s[4:7], s35 offen offset:0 sc1
    buffer_load_dwordx4 a[212:215], v2, s[4:7], s35 offen offset:1024 sc1
    buffer_load_dwordx4 a[216:219], v2, s[4:7], s35 offen offset:2048 sc1
    buffer_load_dwordx4 a[220:223], v2, s[4:7], s35 offen offset:3072 sc1
    buffer_load_dwordx4 a[224:227], v3, s[4:7], s35 offen offset:0 sc1
    buffer_load_dwordx4 a[228:231], v3, s[4:7], s35 offen offset:1024 sc1
    buffer_load_dwordx4 a[232:235], v3, s[4:7], s35 offen offset:2048 sc1
    buffer_load_dwordx4 a[236:239], v3, s[4:7], s35 offen offset:3072 sc1
    buffer_load_dwordx4 a[240:243], v4, s[4:7], s35 offen offset:0 sc1
    buffer_load_dwordx4 a[244:247], v4, s[4:7], s35 offen offset:1024 sc1
    buffer_load_dwordx4 a[248:251], v4, s[4:7], s35 offen offset:2048 sc1
    buffer_load_dwordx4 a[252:255], v4, s[4:7], s35 offen offset:3072 sc1
    buffer_load_dwordx4 v[96:99], v1, s[4:7], s96 offen offset:0 sc1
    buffer_load_dwordx4 v[100:103], v1, s[4:7], s96 offen offset:1024 sc1
    buffer_load_dwordx4 v[104:107], v1, s[4:7], s96 offen offset:2048 sc1
    buffer_load_dwordx4 v[108:111], v1, s[4:7], s96 offen offset:3072 sc1
    buffer_load_dwordx4 v[112:115], v2, s[4:7], s96 offen offset:0 sc1
    buffer_load_dwordx4 v[116:119], v2, s[4:7], s96 offen offset:1024 sc1
    buffer_load_dwordx4 v[120:123], v2, s[4:7], s96 offen offset:2048 sc1
    buffer_load_dwordx4 v[124:127], v2, s[4:7], s96 offen offset:3072 sc1
    buffer_load_dwordx4 v[128:131], v3, s[4:7], s96 offen offset:0 sc1
    buffer_load_dwordx4 v[132:135], v3, s[4:7], s96 offen offset:1024 sc1
    buffer_load_dwordx4 v[136:139], v3, s[4:7], s96 offen offset:2048 sc1
    buffer_load_dwordx4 v[140:143], v3, s[4:7], s96 offen offset:3072 sc1
    buffer_load_dwordx4 v[144:147], v4, s[4:7], s96 offen offset:0 sc1
    buffer_load_dwordx4 v[148:151], v4, s[4:7], s96 offen offset:1024 sc1
    buffer_load_dwordx4 v[152:155], v4, s[4:7], s96 offen offset:2048 sc1
    buffer_load_dwordx4 v[156:159], v4, s[4:7], s96 offen offset:3072 sc1
    s_cmp_ge_u32 s33, 2
    s_cbranch_scc1 L_B_c2
    v_lshlrev_b32 v232, 16, v232
    v_lshlrev_b32 v233, 16, v233
    v_cvt_f32_u32 v160, v249
    v_cvt_f32_u32 v161, s68
    v_mul_f32 v233, v233, v232
    v_add_f32 v160, v160, v161
    v_cvt_f32_i32 v16, v16
    v_cvt_f32_i32 v17, v17
    v_cvt_f32_i32 v18, v18
    v_cvt_f32_i32 v19, v19
    v_cvt_f32_i32 v20, v20
    v_cvt_f32_i32 v21, v21
    v_cvt_f32_i32 v22, v22
    v_cvt_f32_i32 v23, v23
    v_cvt_f32_i32 v24, v24
    v_cvt_f32_i32 v25, v25
    v_cvt_f32_i32 v26, v26
    v_cvt_f32_i32 v27, v27
    v_cvt_f32_i32 v28, v28
    v_cvt_f32_i32 v29, v29
    v_cvt_f32_i32 v30, v30
    v_cvt_f32_i32 v31, v31
    v_cvt_f32_i32 v32, v32
    v_cvt_f32_i32 v33, v33
    v_cvt_f32_i32 v34, v34
    v_cvt_f32_i32 v35, v35
    v_cvt_f32_i32 v36, v36
    v_cvt_f32_i32 v37, v37
    v_cvt_f32_i32 v38, v38
    v_cvt_f32_i32 v39, v39
    v_cvt_f32_i32 v40, v40
    v_cvt_f32_i32 v41, v41
    v_cvt_f32_i32 v42, v42
    v_cvt_f32_i32 v43, v43
    v_cvt_f32_i32 v44, v44
    v_cvt_f32_i32 v45, v45
    v_cvt_f32_i32 v46, v46
    v_cvt_f32_i32 v47, v47
    v_pk_mul_f32 v[170:171], v[200:201], v[160:161] op_sel_hi:[1,0]
    v_pk_mul_f32 v[172:173], v[202:203], v[160:161] op_sel_hi:[1,0]
    v_pk_mul_f32 v[174:175], v[204:205], v[160:161] op_sel_hi:[1,0]
    v_pk_mul_f32 v[176:177], v[206:207], v[160:161] op_sel_hi:[1,0]
    v_fract_f32 v170, v170
    v_fract_f32 v171, v171
    v_fract_f32 v172, v172
    v_fract_f32 v173, v173
    v_fract_f32 v174, v174
    v_fract_f32 v175, v175
    v_fract_f32 v176, v176
    v_fract_f32 v177, v177
    v_cos_f32 v162, v170
    v_cos_f32 v163, v171
    v_cos_f32 v164, v172
    v_cos_f32 v165, v173
    v_cos_f32 v166, v174
    v_cos_f32 v167, v175
    v_cos_f32 v168, v176
    v_cos_f32 v169, v177
    v_sin_f32 v170, v170
    v_sin_f32 v171, v171
    v_sin_f32 v172, v172
    v_sin_f32 v173, v173
    v_sin_f32 v174, v174
    v_sin_f32 v175, v175
    v_sin_f32 v176, v176
    v_sin_f32 v177, v177
    v_pk_fma_f32 v[16:17], v[16:17], v[232:233], v[232:233] op_sel:[0,0,1] op_sel_hi:[1,0,1] neg_lo:[0,0,1] neg_hi:[0,0,1]
    v_pk_fma_f32 v[18:19], v[18:19], v[232:233], v[232:233] op_sel:[0,0,1] op_sel_hi:[1,0,1] neg_lo:[0,0,1] neg_hi:[0,0,1]
    v_pk_fma_f32 v[20:21], v[20:21], v[232:233], v[232:233] op_sel:[0,0,1] op_sel_hi:[1,0,1] neg_lo:[0,0,1] neg_hi:[0,0,1]
    v_pk_fma_f32 v[22:23], v[22:23], v[232:233], v[232:233] op_sel:[0,0,1] op_sel_hi:[1,0,1] neg_lo:[0,0,1] neg_hi:[0,0,1]
    v_pk_fma_f32 v[24:25], v[24:25], v[232:233], v[232:233] op_sel:[0,0,1] op_sel_hi:[1,0,1] neg_lo:[0,0,1] neg_hi:[0,0,1]
    v_pk_fma_f32 v[26:27], v[26:27], v[232:233], v[232:233] op_sel:[0,0,1] op_sel_hi:[1,0,1] neg_lo:[0,0,1] neg_hi:[0,0,1]
    v_pk_fma_f32 v[28:29], v[28:29], v[232:233], v[232:233] op_sel:[0,0,1] op_sel_hi:[1,0,1] neg_lo:[0,0,1] neg_hi:[0,0,1]
    v_pk_fma_f32 v[30:31], v[30:31], v[232:233], v[232:233] op_sel:[0,0,1] op_sel_hi:[1,0,1] neg_lo:[0,0,1] neg_hi:[0,0,1]
    v_pk_fma_f32 v[32:33], v[32:33], v[232:233], v[232:233] op_sel:[0,0,1] op_sel_hi:[1,0,1] neg_lo:[0,0,1] neg_hi:[0,0,1]
    v_pk_fma_f32 v[34:35], v[34:35], v[232:233], v[232:233] op_sel:[0,0,1] op_sel_hi:[1,0,1] neg_lo:[0,0,1] neg_hi:[0,0,1]
    v_pk_fma_f32 v[36:37], v[36:37], v[232:233], v[232:233] op_sel:[0,0,1] op_sel_hi:[1,0,1] neg_lo:[0,0,1] neg_hi:[0,0,1]
    v_pk_fma_f32 v[38:39], v[38:39], v[232:233], v[232:233] op_sel:[0,0,1] op_sel_hi:[1,0,1] neg_lo:[0,0,1] neg_hi:[0,0,1]
    v_pk_fma_f32 v[40:41], v[40:41], v[232:233], v[232:233] op_sel:[0,0,1] op_sel_hi:[1,0,1] neg_lo:[0,0,1] neg_hi:[0,0,1]
    v_pk_fma_f32 v[42:43], v[42:43], v[232:233], v[232:233] op_sel:[0,0,1] op_sel_hi:[1,0,1] neg_lo:[0,0,1] neg_hi:[0,0,1]
    v_pk_fma_f32 v[44:45], v[44:45], v[232:233], v[232:233] op_sel:[0,0,1] op_sel_hi:[1,0,1] neg_lo:[0,0,1] neg_hi:[0,0,1]
    v_pk_fma_f32 v[46:47], v[46:47], v[232:233], v[232:233] op_sel:[0,0,1] op_sel_hi:[1,0,1] neg_lo:[0,0,1] neg_hi:[0,0,1]
    v_pk_mul_f32 v[178:179], v[32:33], v[170:171]
    v_pk_mul_f32 v[180:181], v[34:35], v[172:173]
    v_pk_mul_f32 v[182:183], v[36:37], v[174:175]
    v_pk_mul_f32 v[184:185], v[38:39], v[176:177]
    v_pk_mul_f32 v[170:171], v[16:17], v[170:171]
    v_pk_mul_f32 v[172:173], v[18:19], v[172:173]
    v_pk_mul_f32 v[174:175], v[20:21], v[174:175]
    v_pk_mul_f32 v[176:177], v[22:23], v[176:177]
    v_pk_fma_f32 v[178:179], v[16:17], v[162:163], v[178:179] neg_lo:[0,0,1] neg_hi:[0,0,1]
    v_pk_fma_f32 v[180:181], v[18:19], v[164:165], v[180:181] neg_lo:[0,0,1] neg_hi:[0,0,1]
    v_pk_fma_f32 v[182:183], v[20:21], v[166:167], v[182:183] neg_lo:[0,0,1] neg_hi:[0,0,1]
    v_pk_fma_f32 v[184:185], v[22:23], v[168:169], v[184:185] neg_lo:[0,0,1] neg_hi:[0,0,1]
    v_pk_fma_f32 v[170:171], v[32:33], v[162:163], v[170:171]
    v_pk_fma_f32 v[172:173], v[34:35], v[164:165], v[172:173]
    v_pk_fma_f32 v[174:175], v[36:37], v[166:167], v[174:175]
    v_pk_fma_f32 v[176:177], v[38:39], v[168:169], v[176:177]
    v_cvt_pk_bf16_f32 v16, v178, v179
    v_cvt_pk_bf16_f32 v17, v180, v181
    v_cvt_pk_bf16_f32 v18, v182, v183
    v_cvt_pk_bf16_f32 v19, v184, v185
    v_cvt_pk_bf16_f32 v32, v170, v171
    v_cvt_pk_bf16_f32 v33, v172, v173
    v_cvt_pk_bf16_f32 v34, v174, v175
    v_cvt_pk_bf16_f32 v35, v176, v177
    v_pk_mul_f32 v[170:171], v[208:209], v[160:161] op_sel_hi:[1,0]
    v_pk_mul_f32 v[172:173], v[210:211], v[160:161] op_sel_hi:[1,0]
    v_pk_mul_f32 v[174:175], v[212:213], v[160:161] op_sel_hi:[1,0]
    v_pk_mul_f32 v[176:177], v[214:215], v[160:161] op_sel_hi:[1,0]
    v_fract_f32 v170, v170
    v_fract_f32 v171, v171
    v_fract_f32 v172, v172
    v_fract_f32 v173, v173
    v_fract_f32 v174, v174
    v_fract_f32 v175, v175
    v_fract_f32 v176, v176
    v_fract_f32 v177, v177
    v_cos_f32 v162, v170
    v_cos_f32 v163, v171
    v_cos_f32 v164, v172
    v_cos_f32 v165, v173
    v_cos_f32 v166, v174
    v_cos_f32 v167, v175
    v_cos_f32 v168, v176
    v_cos_f32 v169, v177
    v_sin_f32 v170, v170
    v_sin_f32 v171, v171
    v_sin_f32 v172, v172
    v_sin_f32 v173, v173
    v_sin_f32 v174, v174
    v_sin_f32 v175, v175
    v_sin_f32 v176, v176
    v_sin_f32 v177, v177
    s_nop 0
    v_pk_mul_f32 v[178:179], v[40:41], v[170:171]
    v_pk_mul_f32 v[180:181], v[42:43], v[172:173]
    v_pk_mul_f32 v[182:183], v[44:45], v[174:175]
    v_pk_mul_f32 v[184:185], v[46:47], v[176:177]
    v_pk_mul_f32 v[170:171], v[24:25], v[170:171]
    v_pk_mul_f32 v[172:173], v[26:27], v[172:173]
    v_pk_mul_f32 v[174:175], v[28:29], v[174:175]
    v_pk_mul_f32 v[176:177], v[30:31], v[176:177]
    v_pk_fma_f32 v[178:179], v[24:25], v[162:163], v[178:179] neg_lo:[0,0,1] neg_hi:[0,0,1]
    v_pk_fma_f32 v[180:181], v[26:27], v[164:165], v[180:181] neg_lo:[0,0,1] neg_hi:[0,0,1]
    v_pk_fma_f32 v[182:183], v[28:29], v[166:167], v[182:183] neg_lo:[0,0,1] neg_hi:[0,0,1]
    v_pk_fma_f32 v[184:185], v[30:31], v[168:169], v[184:185] neg_lo:[0,0,1] neg_hi:[0,0,1]
    v_pk_fma_f32 v[170:171], v[40:41], v[162:163], v[170:171]
    v_pk_fma_f32 v[172:173], v[42:43], v[164:165], v[172:173]
    v_pk_fma_f32 v[174:175], v[44:45], v[166:167], v[174:175]
    v_pk_fma_f32 v[176:177], v[46:47], v[168:169], v[176:177]
    v_cvt_pk_bf16_f32 v24, v178, v179
    v_cvt_pk_bf16_f32 v25, v180, v181
    v_cvt_pk_bf16_f32 v26, v182, v183
    v_cvt_pk_bf16_f32 v27, v184, v185
    v_cvt_pk_bf16_f32 v40, v170, v171
    v_cvt_pk_bf16_f32 v41, v172, v173
    v_cvt_pk_bf16_f32 v42, v174, v175
    v_cvt_pk_bf16_f32 v43, v176, v177
    s_lshr_b32 s92, s68, 4
    s_lshl_b32 s92, s92, 13
    s_and_b32 s93, s68, 8
    s_lshl_b32 s93, s93, 4
    s_add_u32 s92, s92, s93
    s_add_u32 s93, s92, 4096
    buffer_store_dwordx4 v[16:19], v250, s[4:7], s92 offen offset:0 sc1
    buffer_store_dwordx4 v[24:27], v250, s[4:7], s92 offen offset:2048 sc1
    buffer_store_dwordx4 v[32:35], v250, s[4:7], s93 offen offset:0 sc1
    buffer_store_dwordx4 v[40:43], v250, s[4:7], s93 offen offset:2048 sc1
    s_branch L_c2_done
L_B_c2:
    v_lshlrev_b32 v160, 16, v232
    v_lshlrev_b32 v161, 16, v236
    v_and_b32 v162, s34, v232
    v_and_b32 v163, s34, v236
    v_lshlrev_b32 v164, 16, v233
    v_lshlrev_b32 v165, 16, v237
    v_and_b32 v166, s34, v233
    v_and_b32 v167, s34, v237
    v_lshlrev_b32 v168, 16, v234
    v_lshlrev_b32 v169, 16, v238
    v_and_b32 v170, s34, v234
    v_and_b32 v171, s34, v238
    v_lshlrev_b32 v172, 16, v235
    v_lshlrev_b32 v173, 16, v239
    v_and_b32 v174, s34, v235
    v_and_b32 v175, s34, v239
    v_cvt_f32_i32 v16, v16
    v_cvt_f32_i32 v17, v17
    v_cvt_f32_i32 v18, v18
    v_cvt_f32_i32 v19, v19
    v_cvt_f32_i32 v20, v20
    v_cvt_f32_i32 v21, v21
    v_cvt_f32_i32 v22, v22
    v_cvt_f32_i32 v23, v23
    v_cvt_f32_i32 v24, v24
    v_cvt_f32_i32 v25, v25
    v_cvt_f32_i32 v26, v26
    v_cvt_f32_i32 v27, v27
    v_cvt_f32_i32 v28, v28
    v_cvt_f32_i32 v29, v29
    v_cvt_f32_i32 v30, v30
    v_cvt_f32_i32 v31, v31
    v_cvt_f32_i32 v32, v32
    v_cvt_f32_i32 v33, v33
    v_cvt_f32_i32 v34, v34
    v_cvt_f32_i32 v35, v35
    v_cvt_f32_i32 v36, v36
    v_cvt_f32_i32 v37, v37
    v_cvt_f32_i32 v38, v38
    v_cvt_f32_i32 v39, v39
    v_cvt_f32_i32 v40, v40
    v_cvt_f32_i32 v41, v41
    v_cvt_f32_i32 v42, v42
    v_cvt_f32_i32 v43, v43
    v_cvt_f32_i32 v44, v44
    v_cvt_f32_i32 v45, v45
    v_cvt_f32_i32 v46, v46
    v_cvt_f32_i32 v47, v47
    v_mul_f32 v161, v161, v160
    v_mul_f32 v163, v163, v162
    v_mul_f32 v165, v165, v164
    v_mul_f32 v167, v167, v166
    v_mul_f32 v169, v169, v168
    v_mul_f32 v171, v171, v170
    v_mul_f32 v173, v173, v172
    v_mul_f32 v175, v175, v174
    v_pk_fma_f32 v[16:17], v[16:17], v[160:161], v[160:161] op_sel:[0,0,1] op_sel_hi:[1,0,1] neg_lo:[0,0,1] neg_hi:[0,0,1]
    v_pk_fma_f32 v[18:19], v[18:19], v[160:161], v[160:161] op_sel:[0,0,1] op_sel_hi:[1,0,1] neg_lo:[0,0,1] neg_hi:[0,0,1]
    v_pk_fma_f32 v[20:21], v[20:21], v[162:163], v[162:163] op_sel:[0,0,1] op_sel_hi:[1,0,1] neg_lo:[0,0,1] neg_hi:[0,0,1]
    v_pk_fma_f32 v[22:23], v[22:23], v[162:163], v[162:163] op_sel:[0,0,1] op_sel_hi:[1,0,1] neg_lo:[0,0,1] neg_hi:[0,0,1]
    v_pk_fma_f32 v[24:25], v[24:25], v[164:165], v[164:165] op_sel:[0,0,1] op_sel_hi:[1,0,1] neg_lo:[0,0,1] neg_hi:[0,0,1]
    v_pk_fma_f32 v[26:27], v[26:27], v[164:165], v[164:165] op_sel:[0,0,1] op_sel_hi:[1,0,1] neg_lo:[0,0,1] neg_hi:[0,0,1]
    v_pk_fma_f32 v[28:29], v[28:29], v[166:167], v[166:167] op_sel:[0,0,1] op_sel_hi:[1,0,1] neg_lo:[0,0,1] neg_hi:[0,0,1]
    v_pk_fma_f32 v[30:31], v[30:31], v[166:167], v[166:167] op_sel:[0,0,1] op_sel_hi:[1,0,1] neg_lo:[0,0,1] neg_hi:[0,0,1]
    v_pk_fma_f32 v[32:33], v[32:33], v[168:169], v[168:169] op_sel:[0,0,1] op_sel_hi:[1,0,1] neg_lo:[0,0,1] neg_hi:[0,0,1]
    v_pk_fma_f32 v[34:35], v[34:35], v[168:169], v[168:169] op_sel:[0,0,1] op_sel_hi:[1,0,1] neg_lo:[0,0,1] neg_hi:[0,0,1]
    v_pk_fma_f32 v[36:37], v[36:37], v[170:171], v[170:171] op_sel:[0,0,1] op_sel_hi:[1,0,1] neg_lo:[0,0,1] neg_hi:[0,0,1]
    v_pk_fma_f32 v[38:39], v[38:39], v[170:171], v[170:171] op_sel:[0,0,1] op_sel_hi:[1,0,1] neg_lo:[0,0,1] neg_hi:[0,0,1]
    v_pk_fma_f32 v[40:41], v[40:41], v[172:173], v[172:173] op_sel:[0,0,1] op_sel_hi:[1,0,1] neg_lo:[0,0,1] neg_hi:[0,0,1]
    v_pk_fma_f32 v[42:43], v[42:43], v[172:173], v[172:173] op_sel:[0,0,1] op_sel_hi:[1,0,1] neg_lo:[0,0,1] neg_hi:[0,0,1]
    v_pk_fma_f32 v[44:45], v[44:45], v[174:175], v[174:175] op_sel:[0,0,1] op_sel_hi:[1,0,1] neg_lo:[0,0,1] neg_hi:[0,0,1]
    v_pk_fma_f32 v[46:47], v[46:47], v[174:175], v[174:175] op_sel:[0,0,1] op_sel_hi:[1,0,1] neg_lo:[0,0,1] neg_hi:[0,0,1]
    v_cvt_pk_bf16_f32 v160, v16, v20
    v_cvt_pk_bf16_f32 v161, v24, v28
    v_cvt_pk_bf16_f32 v162, v32, v36
    v_cvt_pk_bf16_f32 v163, v40, v44
    v_cvt_pk_bf16_f32 v164, v17, v21
    v_cvt_pk_bf16_f32 v165, v25, v29
    v_cvt_pk_bf16_f32 v166, v33, v37
    v_cvt_pk_bf16_f32 v167, v41, v45
    v_cvt_pk_bf16_f32 v168, v18, v22
    v_cvt_pk_bf16_f32 v169, v26, v30
    v_cvt_pk_bf16_f32 v170, v34, v38
    v_cvt_pk_bf16_f32 v171, v42, v46
    v_cvt_pk_bf16_f32 v172, v19, v23
    v_cvt_pk_bf16_f32 v173, v27, v31
    v_cvt_pk_bf16_f32 v174, v35, v39
    v_cvt_pk_bf16_f32 v175, v43, v47
    s_lshr_b32 s92, s69, 2
    s_lshl_b32 s92, s92, 16
    s_lshl_b32 s93, s70, 14
    s_add_u32 s92, s92, s93
    s_sub_u32 s93, s69, s70
    s_and_b32 s93, s93, 3
    s_lshl_b32 s93, s93, 10
    s_add_u32 s92, s92, s93
    buffer_store_dwordx4 v[160:163], v252, s[8:11], s92 offen sc1
    s_add_u32 s92, s92, 4096
    buffer_store_dwordx4 v[164:167], v252, s[8:11], s92 offen sc1
    s_add_u32 s92, s92, 4096
    buffer_store_dwordx4 v[168:171], v252, s[8:11], s92 offen sc1
    s_add_u32 s92, s92, 4096
    buffer_store_dwordx4 v[172:175], v252, s[8:11], s92 offen sc1
L_c2_done:
    s_waitcnt lgkmcnt(0)
    s_waitcnt vmcnt(28)
    v_mfma_f32_16x16x32_bf16 v[16:19], a[192:195], a[64:67], 0
    s_mov_b32 s30, 0
    s_add_u32 s35, s30, 2
    v_mfma_f32_16x16x32_bf16 v[16:19], a[196:199], a[68:71], v[16:19]
    s_add_u32 s96, s35, s31
    s_and_b32 s96, s96, 3
    v_mfma_f32_16x16x32_bf16 v[16:19], a[200:203], a[72:75], v[16:19]
    s_and_b32 s35, s35, 12
    s_or_b32 s35, s35, s96
    v_mfma_f32_16x16x32_bf16 v[16:19], a[204:207], a[76:79], v[16:19]
    s_lshl_b32 s35, s35, 16
    v_mfma_f32_16x16x32_bf16 v[16:19], a[208:211], a[80:83], v[16:19]
    v_mfma_f32_16x16x32_bf16 v[16:19], a[212:215], a[84:87], v[16:19]
    v_mfma_f32_16x16x32_bf16 v[16:19], a[216:219], a[88:91], v[16:19]
    v_mfma_f32_16x16x32_bf16 v[16:19], a[220:223], a[92:95], v[16:19]
    v_mfma_f32_16x16x32_bf16 v[20:23], a[192:195], a[96:99], 0
    v_mfma_f32_16x16x32_bf16 v[20:23], a[196:199], a[100:103], v[20:23]
    v_mfma_f32_16x16x32_bf16 v[20:23], a[200:203], a[104:107], v[20:23]
    v_mfma_f32_16x16x32_bf16 v[20:23], a[204:207], a[108:111], v[20:23]
    v_mfma_f32_16x16x32_bf16 v[20:23], a[208:211], a[112:115], v[20:23]
    v_mfma_f32_16x16x32_bf16 v[20:23], a[212:215], a[116:119], v[20:23]
    v_mfma_f32_16x16x32_bf16 v[20:23], a[216:219], a[120:123], v[20:23]
    v_mfma_f32_16x16x32_bf16 v[20:23], a[220:223], a[124:127], v[20:23]
    v_mfma_f32_16x16x32_bf16 v[24:27], a[192:195], a[128:131], 0
    v_mfma_f32_16x16x32_bf16 v[24:27], a[196:199], a[132:135], v[24:27]
    v_mfma_f32_16x16x32_bf16 v[24:27], a[200:203], a[136:139], v[24:27]
    v_mfma_f32_16x16x32_bf16 v[24:27], a[204:207], a[140:143], v[24:27]
    v_mfma_f32_16x16x32_bf16 v[24:27], a[208:211], a[144:147], v[24:27]
    v_mfma_f32_16x16x32_bf16 v[24:27], a[212:215], a[148:151], v[24:27]
    v_mfma_f32_16x16x32_bf16 v[24:27], a[216:219], a[152:155], v[24:27]
    v_mfma_f32_16x16x32_bf16 v[24:27], a[220:223], a[156:159], v[24:27]
    v_mfma_f32_16x16x32_bf16 v[28:31], a[192:195], a[160:163], 0
    v_mfma_f32_16x16x32_bf16 v[28:31], a[196:199], a[164:167], v[28:31]
    v_mfma_f32_16x16x32_bf16 v[28:31], a[200:203], a[168:171], v[28:31]
    v_mfma_f32_16x16x32_bf16 v[28:31], a[204:207], a[172:175], v[28:31]
    v_mfma_f32_16x16x32_bf16 v[28:31], a[208:211], a[176:179], v[28:31]
    buffer_load_dwordx4 a[192:195], v1, s[4:7], s35 offen offset:0 sc1
    v_mfma_f32_16x16x32_bf16 v[28:31], a[212:215], a[180:183], v[28:31]
    v_mfma_f32_16x16x32_bf16 v[28:31], a[216:219], a[184:187], v[28:31]
    v_mfma_f32_16x16x32_bf16 v[28:31], a[220:223], a[188:191], v[28:31]
    s_waitcnt vmcnt(21)
    v_mfma_f32_16x16x32_bf16 v[32:35], a[224:227], a[64:67], 0
    buffer_load_dwordx4 a[196:199], v1, s[4:7], s35 offen offset:1024 sc1
    v_mfma_f32_16x16x32_bf16 v[32:35], a[228:231], a[68:71], v[32:35]
    v_mfma_f32_16x16x32_bf16 v[32:35], a[232:235], a[72:75], v[32:35]
    v_mfma_f32_16x16x32_bf16 v[32:35], a[236:239], a[76:79], v[32:35]
    v_mfma_f32_16x16x32_bf16 v[32:35], a[240:243], a[80:83], v[32:35]
    buffer_load_dwordx4 a[200:203], v1, s[4:7], s35 offen offset:2048 sc1
    v_mfma_f32_16x16x32_bf16 v[32:35], a[244:247], a[84:87], v[32:35]
    v_mfma_f32_16x16x32_bf16 v[32:35], a[248:251], a[88:91], v[32:35]
    v_mfma_f32_16x16x32_bf16 v[32:35], a[252:255], a[92:95], v[32:35]
    v_mfma_f32_16x16x32_bf16 v[36:39], a[224:227], a[96:99], 0
    buffer_load_dwordx4 a[204:207], v1, s[4:7], s35 offen offset:3072 sc1
    v_mfma_f32_16x16x32_bf16 v[36:39], a[228:231], a[100:103], v[36:39]
    v_mfma_f32_16x16x32_bf16 v[36:39], a[232:235], a[104:107], v[36:39]
    v_mfma_f32_16x16x32_bf16 v[36:39], a[236:239], a[108:111], v[36:39]
    v_mfma_f32_16x16x32_bf16 v[36:39], a[240:243], a[112:115], v[36:39]
    buffer_load_dwordx4 a[208:211], v2, s[4:7], s35 offen offset:0 sc1
    v_mfma_f32_16x16x32_bf16 v[36:39], a[244:247], a[116:119], v[36:39]
    v_mfma_f32_16x16x32_bf16 v[36:39], a[248:251], a[120:123], v[36:39]
    v_mfma_f32_16x16x32_bf16 v[36:39], a[252:255], a[124:127], v[36:39]
    v_mfma_f32_16x16x32_bf16 v[40:43], a[224:227], a[128:131], 0
    buffer_load_dwordx4 a[212:215], v2, s[4:7], s35 offen offset:1024 sc1
    v_mfma_f32_16x16x32_bf16 v[40:43], a[228:231], a[132:135], v[40:43]
    v_mfma_f32_16x16x32_bf16 v[40:43], a[232:235], a[136:139], v[40:43]
    v_mfma_f32_16x16x32_bf16 v[40:43], a[236:239], a[140:143], v[40:43]
    v_mfma_f32_16x16x32_bf16 v[40:43], a[240:243], a[144:147], v[40:43]
    buffer_load_dwordx4 a[216:219], v2, s[4:7], s35 offen offset:2048 sc1
    v_mfma_f32_16x16x32_bf16 v[40:43], a[244:247], a[148:151], v[40:43]
    v_mfma_f32_16x16x32_bf16 v[40:43], a[248:251], a[152:155], v[40:43]
    v_mfma_f32_16x16x32_bf16 v[40:43], a[252:255], a[156:159], v[40:43]
    v_mfma_f32_16x16x32_bf16 v[44:47], a[224:227], a[160:163], 0
    buffer_load_dwordx4 a[220:223], v2, s[4:7], s35 offen offset:3072 sc1
    v_mfma_f32_16x16x32_bf16 v[44:47], a[228:231], a[164:167], v[44:47]
    v_mfma_f32_16x16x32_bf16 v[44:47], a[232:235], a[168:171], v[44:47]
    v_mfma_f32_16x16x32_bf16 v[44:47], a[236:239], a[172:175], v[44:47]
    v_mfma_f32_16x16x32_bf16 v[44:47], a[240:243], a[176:179], v[44:47]
    v_mfma_f32_16x16x32_bf16 v[44:47], a[244:247], a[180:183], v[44:47]
    v_mfma_f32_16x16x32_bf16 v[44:47], a[248:251], a[184:187], v[44:47]
    v_mfma_f32_16x16x32_bf16 v[44:47], a[252:255], a[188:191], v[44:47]
    s_waitcnt vmcnt(20)
    v_mfma_f32_16x16x32_bf16 v[48:51], v[96:99], a[64:67], 0
    buffer_load_dwordx4 a[224:227], v3, s[4:7], s35 offen offset:0 sc1
    v_mfma_f32_16x16x32_bf16 v[48:51], v[100:103], a[68:71], v[48:51]
    v_mfma_f32_16x16x32_bf16 v[48:51], v[104:107], a[72:75], v[48:51]
    v_mfma_f32_16x16x32_bf16 v[48:51], v[108:111], a[76:79], v[48:51]
    v_mfma_f32_16x16x32_bf16 v[48:51], v[112:115], a[80:83], v[48:51]
    buffer_load_dwordx4 a[228:231], v3, s[4:7], s35 offen offset:1024 sc1
    v_mfma_f32_16x16x32_bf16 v[48:51], v[116:119], a[84:87], v[48:51]
    v_exp_f32 v16, v16
    v_mfma_f32_16x16x32_bf16 v[48:51], v[120:123], a[88:91], v[48:51]
    v_exp_f32 v17, v17
    v_mfma_f32_16x16x32_bf16 v[48:51], v[124:127], a[92:95], v[48:51]
    v_exp_f32 v18, v18
    v_mfma_f32_16x16x32_bf16 v[52:55], v[96:99], a[96:99], 0
    buffer_load_dwordx4 a[232:235], v3, s[4:7], s35 offen offset:2048 sc1
    v_add_f32 v9, v9, v16
    v_mfma_f32_16x16x32_bf16 v[52:55], v[100:103], a[100:103], v[52:55]
    v_exp_f32 v19, v19
    v_mfma_f32_16x16x32_bf16 v[52:55], v[104:107], a[104:107], v[52:55]
    v_add_f32 v9, v9, v17
    v_cvt_pk_bf16_f32 v80, v16, v17
    v_mfma_f32_16x16x32_bf16 v[52:55], v[108:111], a[108:111], v[52:55]
    v_exp_f32 v32, v32
    v_mfma_f32_16x16x32_bf16 v[52:55], v[112:115], a[112:115], v[52:55]
    buffer_load_dwordx4 a[236:239], v3, s[4:7], s35 offen offset:3072 sc1
    v_add_f32 v9, v9, v18
    v_mfma_f32_16x16x32_bf16 v[52:55], v[116:119], a[116:119], v[52:55]
    v_exp_f32 v33, v33
    v_mfma_f32_16x16x32_bf16 v[52:55], v[120:123], a[120:123], v[52:55]
    v_add_f32 v9, v9, v19
    v_cvt_pk_bf16_f32 v81, v18, v19
    v_mfma_f32_16x16x32_bf16 v[52:55], v[124:127], a[124:127], v[52:55]
    v_exp_f32 v34, v34
    v_mfma_f32_16x16x32_bf16 v[56:59], v[96:99], a[128:131], 0
    buffer_load_dwordx4 a[240:243], v4, s[4:7], s35 offen offset:0 sc1
    v_add_f32 v9, v9, v32
    v_mfma_f32_16x16x32_bf16 v[56:59], v[100:103], a[132:135], v[56:59]
    v_exp_f32 v35, v35
    v_mfma_f32_16x16x32_bf16 v[56:59], v[104:107], a[136:139], v[56:59]
    v_add_f32 v9, v9, v33
    v_cvt_pk_bf16_f32 v82, v32, v33
    v_mfma_f32_16x16x32_bf16 v[56:59], v[108:111], a[140:143], v[56:59]
    v_exp_f32 v20, v20
    v_mfma_f32_16x16x32_bf16 v[56:59], v[112:115], a[144:147], v[56:59]
    buffer_load_dwordx4 a[244:247], v4, s[4:7], s35 offen offset:1024 sc1
    v_add_f32 v9, v9, v34
    v_mfma_f32_16x16x32_bf16 v[56:59], v[116:119], a[148:151], v[56:59]
    v_exp_f32 v21, v21
    v_mfma_f32_16x16x32_bf16 v[56:59], v[120:123], a[152:155], v[56:59]
    v_add_f32 v9, v9, v35
    v_cvt_pk_bf16_f32 v83, v34, v35
    v_mfma_f32_16x16x32_bf16 v[56:59], v[124:127], a[156:159], v[56:59]
    ds_write_b128 v5, v[80:83] offset:0
    v_mfma_f32_16x16x32_bf16 v[60:63], v[96:99], a[160:163], 0
    buffer_load_dwordx4 a[248:251], v4, s[4:7], s35 offen offset:2048 sc1
    v_mfma_f32_16x16x32_bf16 v[60:63], v[100:103], a[164:167], v[60:63]
    v_exp_f32 v22, v22
    v_mfma_f32_16x16x32_bf16 v[60:63], v[104:107], a[168:171], v[60:63]
    v_add_f32 v10, v10, v20
    v_mfma_f32_16x16x32_bf16 v[60:63], v[108:111], a[172:175], v[60:63]
    v_exp_f32 v23, v23
    v_mfma_f32_16x16x32_bf16 v[60:63], v[112:115], a[176:179], v[60:63]
    buffer_load_dwordx4 a[252:255], v4, s[4:7], s35 offen offset:3072 sc1
    buffer_load_dwordx4 v[160:163], v1, s[8:11], s29 offen offset:0 sc1
    v_mfma_f32_16x16x32_bf16 v[60:63], v[116:119], a[180:183], v[60:63]
    v_add_f32 v10, v10, v21
    v_cvt_pk_bf16_f32 v84, v20, v21
    v_mfma_f32_16x16x32_bf16 v[60:63], v[120:123], a[184:187], v[60:63]
    v_exp_f32 v36, v36
    v_mfma_f32_16x16x32_bf16 v[60:63], v[124:127], a[188:191], v[60:63]
    v_add_f32 v10, v10, v22
    s_waitcnt vmcnt(21)
    v_mfma_f32_16x16x32_bf16 v[64:67], v[128:131], a[64:67], 0
    buffer_load_dwordx4 v[164:167], v1, s[8:11], s29 offen offset:1024 sc1
    v_mfma_f32_16x16x32_bf16 v[64:67], v[132:135], a[68:71], v[64:67]
    v_exp_f32 v37, v37
    v_mfma_f32_16x16x32_bf16 v[64:67], v[136:139], a[72:75], v[64:67]
    v_add_f32 v10, v10, v23
    v_cvt_pk_bf16_f32 v85, v22, v23
    v_mfma_f32_16x16x32_bf16 v[64:67], v[140:143], a[76:79], v[64:67]
    v_exp_f32 v38, v38
    v_mfma_f32_16x16x32_bf16 v[64:67], v[144:147], a[80:83], v[64:67]
    buffer_load_dwordx4 v[168:171], v1, s[8:11], s29 offen offset:2048 sc1
    v_add_f32 v10, v10, v36
    v_mfma_f32_16x16x32_bf16 v[64:67], v[148:151], a[84:87], v[64:67]
    v_exp_f32 v39, v39
    v_mfma_f32_16x16x32_bf16 v[64:67], v[152:155], a[88:91], v[64:67]
    v_add_f32 v10, v10, v37
    v_cvt_pk_bf16_f32 v86, v36, v37
    v_mfma_f32_16x16x32_bf16 v[64:67], v[156:159], a[92:95], v[64:67]
    v_exp_f32 v24, v24
    v_mfma_f32_16x16x32_bf16 v[68:71], v[128:131], a[96:99], 0
    buffer_load_dwordx4 v[172:175], v1, s[8:11], s29 offen offset:3072 sc1
    v_add_f32 v10, v10, v38
    v_mfma_f32_16x16x32_bf16 v[68:71], v[132:135], a[100:103], v[68:71]
    v_exp_f32 v25, v25
    v_mfma_f32_16x16x32_bf16 v[68:71], v[136:139], a[104:107], v[68:71]
    v_add_f32 v10, v10, v39
    v_cvt_pk_bf16_f32 v87, v38, v39
    v_mfma_f32_16x16x32_bf16 v[68:71], v[140:143], a[108:111], v[68:71]
    ds_write_b128 v5, v[84:87] offset:1024
    v_mfma_f32_16x16x32_bf16 v[68:71], v[144:147], a[112:115], v[68:71]
    buffer_load_dwordx4 v[176:179], v2, s[8:11], s29 offen offset:0 sc1
    v_mfma_f32_16x16x32_bf16 v[68:71], v[148:151], a[116:119], v[68:71]
    v_exp_f32 v26, v26
    v_mfma_f32_16x16x32_bf16 v[68:71], v[152:155], a[120:123], v[68:71]
    v_add_f32 v11, v11, v24
    v_mfma_f32_16x16x32_bf16 v[68:71], v[156:159], a[124:127], v[68:71]
    v_exp_f32 v27, v27
    v_mfma_f32_16x16x32_bf16 v[72:75], v[128:131], a[128:131], 0
    buffer_load_dwordx4 v[180:183], v2, s[8:11], s29 offen offset:1024 sc1
    v_add_f32 v11, v11, v25
    v_mfma_f32_16x16x32_bf16 v[72:75], v[132:135], a[132:135], v[72:75]
    v_cvt_pk_bf16_f32 v88, v24, v25
    v_mfma_f32_16x16x32_bf16 v[72:75], v[136:139], a[136:139], v[72:75]
    v_exp_f32 v40, v40
    v_mfma_f32_16x16x32_bf16 v[72:75], v[140:143], a[140:143], v[72:75]
    v_add_f32 v11, v11, v26
    v_mfma_f32_16x16x32_bf16 v[72:75], v[144:147], a[144:147], v[72:75]
    buffer_load_dwordx4 v[184:187], v2, s[8:11], s29 offen offset:2048 sc1
    v_mfma_f32_16x16x32_bf16 v[72:75], v[148:151], a[148:151], v[72:75]
    v_exp_f32 v41, v41
    v_mfma_f32_16x16x32_bf16 v[72:75], v[152:155], a[152:155], v[72:75]
    v_add_f32 v11, v11, v27
    v_cvt_pk_bf16_f32 v89, v26, v27
    v_mfma_f32_16x16x32_bf16 v[72:75], v[156:159], a[156:159], v[72:75]
    v_exp_f32 v42, v42
    v_mfma_f32_16x16x32_bf16 v[76:79], v[128:131], a[160:163], 0
    buffer_load_dwordx4 v[188:191], v2, s[8:11], s29 offen offset:3072 sc1
    v_add_f32 v11, v11, v40
    v_mfma_f32_16x16x32_bf16 v[76:79], v[132:135], a[164:167], v[76:79]
    v_exp_f32 v43, v43
    v_mfma_f32_16x16x32_bf16 v[76:79], v[136:139], a[168:171], v[76:79]
    v_add_f32 v11, v11, v41
    v_cvt_pk_bf16_f32 v90, v40, v41
    v_mfma_f32_16x16x32_bf16 v[76:79], v[140:143], a[172:175], v[76:79]
    v_exp_f32 v28, v28
    v_mfma_f32_16x16x32_bf16 v[76:79], v[144:147], a[176:179], v[76:79]
    buffer_load_dwordx4 v[192:195], v3, s[8:11], s29 offen offset:0 sc1
    v_add_f32 v11, v11, v42
    v_mfma_f32_16x16x32_bf16 v[76:79], v[148:151], a[180:183], v[76:79]
    v_exp_f32 v29, v29
    v_mfma_f32_16x16x32_bf16 v[76:79], v[152:155], a[184:187], v[76:79]
    v_add_f32 v11, v11, v43
    v_cvt_pk_bf16_f32 v91, v42, v43
    v_mfma_f32_16x16x32_bf16 v[76:79], v[156:159], a[188:191], v[76:79]
    ds_write_b128 v5, v[88:91] offset:2048
    v_exp_f32 v30, v30
    v_add_f32 v12, v12, v28
    v_exp_f32 v31, v31
    v_add_f32 v12, v12, v29
    v_cvt_pk_bf16_f32 v92, v28, v29
    v_exp_f32 v44, v44
    v_add_f32 v12, v12, v30
    v_exp_f32 v45, v45
    v_add_f32 v12, v12, v31
    v_cvt_pk_bf16_f32 v93, v30, v31
    v_exp_f32 v46, v46
    v_add_f32 v12, v12, v44
    v_exp_f32 v47, v47
    v_add_f32 v12, v12, v45
    v_cvt_pk_bf16_f32 v94, v44, v45
    s_nop 0
    v_add_f32 v12, v12, v46
    v_add_f32 v12, v12, v47
    v_cvt_pk_bf16_f32 v95, v46, v47
    ds_write_b128 v5, v[92:95] offset:3072
    s_waitcnt vmcnt(25)
    s_waitcnt lgkmcnt(0)
    s_barrier
    s_mov_b32 s30, 1
    s_cmp_lg_u32 s33, 0
    s_cbranch_scc1 L_pub3
    s_mov_b64 exec, 1
    s_add_u32 s93, s39, 3
    v_mov_b32 v158, s93
    s_lshl_b32 s92, s99, 5
    s_add_u32 s92, s92, s90
    s_lshl_b32 s92, s92, 7
    v_mov_b32 v159, s92
    global_store_dword v159, v158, s[50:51] sc1
    s_mov_b64 exec, -1
L_pub3:
    s_bitcmp1_b32 s38, s30
    s_cbranch_scc0 L_nohook_it0
    s_call_b64 s[66:67], L_hook
L_nohook_it0:
L_loop:
    s_waitcnt vmcnt(17)
    v_mfma_f32_16x16x32_bf16 v[16:19], a[192:195], a[64:67], 0
    buffer_load_dwordx4 v[196:199], v3, s[8:11], s29 offen offset:1024 sc1
    s_add_u32 s28, s30, 2
    v_mfma_f32_16x16x32_bf16 v[16:19], a[196:199], a[68:71], v[16:19]
    s_add_u32 s96, s28, s31
    s_and_b32 s96, s96, 3
    v_mfma_f32_16x16x32_bf16 v[16:19], a[200:203], a[72:75], v[16:19]
    s_and_b32 s28, s28, 12
    s_or_b32 s28, s28, s96
    v_mfma_f32_16x16x32_bf16 v[16:19], a[204:207], a[76:79], v[16:19]
    s_lshl_b32 s28, s28, 16
    s_cmp_lt_u32 s30, 14
    v_mfma_f32_16x16x32_bf16 v[16:19], a[208:211], a[80:83], v[16:19]
    buffer_load_dwordx4 v[200:203], v3, s[8:11], s29 offen offset:2048 sc1
    s_cselect_b32 s35, s28, 0x100000
    v_mfma_f32_16x16x32_bf16 v[16:19], a[212:215], a[84:87], v[16:19]
    ds_read_b128 v[112:115], v6 offset:0
    v_mfma_f32_16x16x32_bf16 v[16:19], a[216:219], a[88:91], v[16:19]
    ds_read_b128 v[116:119], v6 offset:1024
    v_mfma_f32_16x16x32_bf16 v[16:19], a[220:223], a[92:95], v[16:19]
    ds_read_b128 v[120:123], v6 offset:2048
    v_mfma_f32_16x16x32_bf16 v[20:23], a[192:195], a[96:99], 0
    buffer_load_dwordx4 v[204:207], v3, s[8:11], s29 offen offset:3072 sc1
    ds_read_b128 v[124:127], v6 offset:3072
    v_mfma_f32_16x16x32_bf16 v[20:23], a[196:199], a[100:103], v[20:23]
    ds_read_b128 v[128:131], v7 offset:0
    v_mfma_f32_16x16x32_bf16 v[20:23], a[200:203], a[104:107], v[20:23]
    ds_read_b128 v[132:135], v7 offset:1024
    v_mfma_f32_16x16x32_bf16 v[20:23], a[204:207], a[108:111], v[20:23]
    ds_read_b128 v[136:139], v7 offset:2048
    v_mfma_f32_16x16x32_bf16 v[20:23], a[208:211], a[112:115], v[20:23]
    buffer_load_dwordx4 v[208:211], v4, s[8:11], s29 offen offset:0 sc1
    ds_read_b128 v[140:143], v7 offset:3072
    v_mfma_f32_16x16x32_bf16 v[20:23], a[212:215], a[116:119], v[20:23]
    ds_read_b128 v[144:147], v8 offset:0
    v_mfma_f32_16x16x32_bf16 v[20:23], a[216:219], a[120:123], v[20:23]
    ds_read_b128 v[148:151], v8 offset:1024
    v_mfma_f32_16x16x32_bf16 v[20:23], a[220:223], a[124:127], v[20:23]
    ds_read_b128 v[152:155], v8 offset:2048
    v_mfma_f32_16x16x32_bf16 v[24:27], a[192:195], a[128:131], 0
    buffer_load_dwordx4 v[212:215], v4, s[8:11], s29 offen offset:1024 sc1
    ds_read_b128 v[156:159], v8 offset:3072
    v_mfma_f32_16x16x32_bf16 v[24:27], a[196:199], a[132:135], v[24:27]
    v_exp_f32 v48, v48
    v_mfma_f32_16x16x32_bf16 v[24:27], a[200:203], a[136:139], v[24:27]
    v_exp_f32 v49, v49
    v_mfma_f32_16x16x32_bf16 v[24:27], a[204:207], a[140:143], v[24:27]
    v_exp_f32 v50, v50
    v_mfma_f32_16x16x32_bf16 v[24:27], a[208:211], a[144:147], v[24:27]
    buffer_load_dwordx4 v[216:219], v4, s[8:11], s29 offen offset:2048 sc1
    v_add_f32 v9, v9, v48
    v_mfma_f32_16x16x32_bf16 v[24:27], a[212:215], a[148:151], v[24:27]
    v_exp_f32 v51, v51
    v_mfma_f32_16x16x32_bf16 v[24:27], a[216:219], a[152:155], v[24:27]
    v_add_f32 v9, v9, v49
    v_cvt_pk_bf16_f32 v96, v48, v49
    v_mfma_f32_16x16x32_bf16 v[24:27], a[220:223], a[156:159], v[24:27]
    v_exp_f32 v64, v64
    v_mfma_f32_16x16x32_bf16 v[28:31], a[192:195], a[160:163], 0
    buffer_load_dwordx4 v[220:223], v4, s[8:11], s29 offen offset:3072 sc1
    v_add_f32 v9, v9, v50
    v_mfma_f32_16x16x32_bf16 v[28:31], a[196:199], a[164:167], v[28:31]
    v_exp_f32 v65, v65
    v_mfma_f32_16x16x32_bf16 v[28:31], a[200:203], a[168:171], v[28:31]
    v_add_f32 v9, v9, v51
    v_cvt_pk_bf16_f32 v97, v50, v51
    v_mfma_f32_16x16x32_bf16 v[28:31], a[204:207], a[172:175], v[28:31]
    v_mfma_f32_16x16x32_bf16 v[28:31], a[208:211], a[176:179], v[28:31]
    buffer_load_dwordx4 a[192:195], v1, s[4:7], s35 offen offset:0 sc1
    v_mfma_f32_16x16x32_bf16 v[28:31], a[212:215], a[180:183], v[28:31]
    v_exp_f32 v66, v66
    v_mfma_f32_16x16x32_bf16 v[28:31], a[216:219], a[184:187], v[28:31]
    v_add_f32 v9, v9, v64
    v_mfma_f32_16x16x32_bf16 v[28:31], a[220:223], a[188:191], v[28:31]
    s_waitcnt vmcnt(17)
    v_mfma_f32_16x16x32_bf16 v[32:35], a[224:227], a[64:67], 0
    buffer_load_dwordx4 a[196:199], v1, s[4:7], s35 offen offset:1024 sc1
    v_mfma_f32_16x16x32_bf16 v[32:35], a[228:231], a[68:71], v[32:35]
    v_exp_f32 v67, v67
    v_mfma_f32_16x16x32_bf16 v[32:35], a[232:235], a[72:75], v[32:35]
    v_add_f32 v9, v9, v65
    v_cvt_pk_bf16_f32 v98, v64, v65
    v_mfma_f32_16x16x32_bf16 v[32:35], a[236:239], a[76:79], v[32:35]
    v_exp_f32 v52, v52
    v_mfma_f32_16x16x32_bf16 v[32:35], a[240:243], a[80:83], v[32:35]
    buffer_load_dwordx4 a[200:203], v1, s[4:7], s35 offen offset:2048 sc1
    v_add_f32 v9, v9, v66
    v_mfma_f32_16x16x32_bf16 v[32:35], a[244:247], a[84:87], v[32:35]
    v_exp_f32 v53, v53
    v_mfma_f32_16x16x32_bf16 v[32:35], a[248:251], a[88:91], v[32:35]
    v_add_f32 v9, v9, v67
    v_mfma_f32_16x16x32_bf16 v[32:35], a[252:255], a[92:95], v[32:35]
    v_cvt_pk_bf16_f32 v99, v66, v67
    ds_write_b128 v5, v[96:99] offset:16384
    v_mfma_f32_16x16x32_bf16 v[36:39], a[224:227], a[96:99], 0
    buffer_load_dwordx4 a[204:207], v1, s[4:7], s35 offen offset:3072 sc1
    v_mfma_f32_16x16x32_bf16 v[36:39], a[228:231], a[100:103], v[36:39]
    s_add_u32 s29, s30, 0
    v_mfma_f32_16x16x32_bf16 v[36:39], a[232:235], a[104:107], v[36:39]
    s_add_u32 s95, s29, s31
    v_mfma_f32_16x16x32_bf16 v[36:39], a[236:239], a[108:111], v[36:39]
    s_and_b32 s95, s95, 3
    v_mfma_f32_16x16x32_bf16 v[36:39], a[240:243], a[112:115], v[36:39]
    buffer_load_dwordx4 a[208:211], v2, s[4:7], s35 offen offset:0 sc1
    s_and_b32 s29, s29, 12
    v_mfma_f32_16x16x32_bf16 v[36:39], a[244:247], a[116:119], v[36:39]
    s_or_b32 s29, s29, s95
    v_mfma_f32_16x16x32_bf16 v[36:39], a[248:251], a[120:123], v[36:39]
    s_lshl_b32 s29, s29, 16
    v_mfma_f32_16x16x32_bf16 v[36:39], a[252:255], a[124:127], v[36:39]
    v_exp_f32 v54, v54
    v_mfma_f32_16x16x32_bf16 v[40:43], a[224:227], a[128:131], 0
    buffer_load_dwordx4 a[212:215], v2, s[4:7], s35 offen offset:1024 sc1
    v_add_f32 v10, v10, v52
    v_mfma_f32_16x16x32_bf16 v[40:43], a[228:231], a[132:135], v[40:43]
    v_exp_f32 v55, v55
    v_mfma_f32_16x16x32_bf16 v[40:43], a[232:235], a[136:139], v[40:43]
    v_add_f32 v10, v10, v53
    v_cvt_pk_bf16_f32 v100, v52, v53
    v_mfma_f32_16x16x32_bf16 v[40:43], a[236:239], a[140:143], v[40:43]
    v_exp_f32 v68, v68
    v_mfma_f32_16x16x32_bf16 v[40:43], a[240:243], a[144:147], v[40:43]
    buffer_load_dwordx4 a[216:219], v2, s[4:7], s35 offen offset:2048 sc1
    v_add_f32 v10, v10, v54
    v_mfma_f32_16x16x32_bf16 v[40:43], a[244:247], a[148:151], v[40:43]
    v_exp_f32 v69, v69
    v_mfma_f32_16x16x32_bf16 v[40:43], a[248:251], a[152:155], v[40:43]
    v_add_f32 v10, v10, v55
    v_mfma_f32_16x16x32_bf16 v[40:43], a[252:255], a[156:159], v[40:43]
    v_cvt_pk_bf16_f32 v101, v54, v55
    v_mfma_f32_16x16x32_bf16 v[44:47], a[224:227], a[160:163], 0
    buffer_load_dwordx4 a[220:223], v2, s[4:7], s35 offen offset:3072 sc1
    v_mfma_f32_16x16x32_bf16 v[44:47], a[228:231], a[164:167], v[44:47]
    s_bitcmp1_b32 s49, s30
    s_cbranch_scc0 L_noflagld
    global_load_dword v13, v14, s[50:51] sc1
L_noflagld:
    v_mfma_f32_16x16x32_bf16 v[44:47], a[232:235], a[168:171], v[44:47]
    v_exp_f32 v70, v70
    v_mfma_f32_16x16x32_bf16 v[44:47], a[236:239], a[172:175], v[44:47]
    v_add_f32 v10, v10, v68
    v_mfma_f32_16x16x32_bf16 v[44:47], a[240:243], a[176:179], v[44:47]
    buffer_load_dwordx4 a[224:227], v3, s[4:7], s35 offen offset:0 sc1
    v_mfma_f32_16x16x32_bf16 v[44:47], a[244:247], a[180:183], v[44:47]
    v_exp_f32 v71, v71
    v_mfma_f32_16x16x32_bf16 v[44:47], a[248:251], a[184:187], v[44:47]
    v_add_f32 v10, v10, v69
    v_cvt_pk_bf16_f32 v102, v68, v69
    v_mfma_f32_16x16x32_bf16 v[44:47], a[252:255], a[188:191], v[44:47]
    s_waitcnt vmcnt(21)
    v_mfma_f32_16x16x32_bf16 a[0:3], v[160:163], v[80:83], a[0:3]
    buffer_load_dwordx4 a[228:231], v3, s[4:7], s35 offen offset:1024 sc1
    s_waitcnt lgkmcnt(1)
    v_mfma_f32_16x16x32_bf16 a[0:3], v[164:167], v[112:115], a[0:3]
    v_exp_f32 v56, v56
    v_mfma_f32_16x16x32_bf16 a[0:3], v[168:171], v[128:131], a[0:3]
    v_add_f32 v10, v10, v70
    v_mfma_f32_16x16x32_bf16 a[0:3], v[172:175], v[144:147], a[0:3]
    v_exp_f32 v57, v57
    v_mfma_f32_16x16x32_bf16 a[4:7], v[160:163], v[84:87], a[4:7]
    buffer_load_dwordx4 a[232:235], v3, s[4:7], s35 offen offset:2048 sc1
    v_add_f32 v10, v10, v71
    v_mfma_f32_16x16x32_bf16 a[4:7], v[164:167], v[116:119], a[4:7]
    v_cvt_pk_bf16_f32 v103, v70, v71
    ds_write_b128 v5, v[100:103] offset:17408
    v_mfma_f32_16x16x32_bf16 a[4:7], v[168:171], v[132:135], a[4:7]
    v_mfma_f32_16x16x32_bf16 a[4:7], v[172:175], v[148:151], a[4:7]
    v_exp_f32 v58, v58
    v_mfma_f32_16x16x32_bf16 a[8:11], v[160:163], v[88:91], a[8:11]
    buffer_load_dwordx4 a[236:239], v3, s[4:7], s35 offen offset:3072 sc1
    v_add_f32 v11, v11, v56
    v_mfma_f32_16x16x32_bf16 a[8:11], v[164:167], v[120:123], a[8:11]
    v_mfma_f32_16x16x32_bf16 a[8:11], v[168:171], v[136:139], a[8:11]
    v_exp_f32 v59, v59
    v_mfma_f32_16x16x32_bf16 a[8:11], v[172:175], v[152:155], a[8:11]
    v_add_f32 v11, v11, v57
    v_cvt_pk_bf16_f32 v104, v56, v57
    v_mfma_f32_16x16x32_bf16 a[12:15], v[160:163], v[92:95], a[12:15]
    buffer_load_dwordx4 a[240:243], v4, s[4:7], s35 offen offset:0 sc1
    v_mfma_f32_16x16x32_bf16 a[12:15], v[164:167], v[124:127], a[12:15]
    v_exp_f32 v72, v72
    v_mfma_f32_16x16x32_bf16 a[12:15], v[168:171], v[140:143], a[12:15]
    v_add_f32 v11, v11, v58
    v_mfma_f32_16x16x32_bf16 a[12:15], v[172:175], v[156:159], a[12:15]
    s_waitcnt vmcnt(21)
    v_mfma_f32_16x16x32_bf16 a[16:19], v[176:179], v[80:83], a[16:19]
    buffer_load_dwordx4 a[244:247], v4, s[4:7], s35 offen offset:1024 sc1
    v_mfma_f32_16x16x32_bf16 a[16:19], v[180:183], v[112:115], a[16:19]
    v_exp_f32 v73, v73
    v_mfma_f32_16x16x32_bf16 a[16:19], v[184:187], v[128:131], a[16:19]
    v_add_f32 v11, v11, v59
    v_cvt_pk_bf16_f32 v105, v58, v59
    v_mfma_f32_16x16x32_bf16 a[16:19], v[188:191], v[144:147], a[16:19]
    v_exp_f32 v74, v74
    v_mfma_f32_16x16x32_bf16 a[20:23], v[176:179], v[84:87], a[20:23]
    buffer_load_dwordx4 a[248:251], v4, s[4:7], s35 offen offset:2048 sc1
    v_add_f32 v11, v11, v72
    v_mfma_f32_16x16x32_bf16 a[20:23], v[180:183], v[116:119], a[20:23]
    v_mfma_f32_16x16x32_bf16 a[20:23], v[184:187], v[132:135], a[20:23]
    v_exp_f32 v75, v75
    v_mfma_f32_16x16x32_bf16 a[20:23], v[188:191], v[148:151], a[20:23]
    v_add_f32 v11, v11, v73
    v_cvt_pk_bf16_f32 v106, v72, v73
    v_mfma_f32_16x16x32_bf16 a[24:27], v[176:179], v[88:91], a[24:27]
    buffer_load_dwordx4 a[252:255], v4, s[4:7], s35 offen offset:3072 sc1
    v_mfma_f32_16x16x32_bf16 a[24:27], v[180:183], v[120:123], a[24:27]
    v_exp_f32 v60, v60
    v_mfma_f32_16x16x32_bf16 a[24:27], v[184:187], v[136:139], a[24:27]
    v_add_f32 v11, v11, v74
    v_mfma_f32_16x16x32_bf16 a[24:27], v[188:191], v[152:155], a[24:27]
    v_mfma_f32_16x16x32_bf16 a[28:31], v[176:179], v[92:95], a[28:31]
    buffer_load_dwordx4 v[160:163], v1, s[8:11], s29 offen offset:0 sc1
    v_mfma_f32_16x16x32_bf16 a[28:31], v[180:183], v[124:127], a[28:31]
    v_exp_f32 v61, v61
    v_mfma_f32_16x16x32_bf16 a[28:31], v[184:187], v[140:143], a[28:31]
    v_add_f32 v11, v11, v75
    v_cvt_pk_bf16_f32 v107, v74, v75
    v_mfma_f32_16x16x32_bf16 a[28:31], v[188:191], v[156:159], a[28:31]
    ds_write_b128 v5, v[104:107] offset:18432
    s_waitcnt vmcnt(21)
    v_mfma_f32_16x16x32_bf16 a[32:35], v[192:195], v[80:83], a[32:35]
    buffer_load_dwordx4 v[164:167], v1, s[8:11], s29 offen offset:1024 sc1
    v_mfma_f32_16x16x32_bf16 a[32:35], v[196:199], v[112:115], a[32:35]
    v_exp_f32 v62, v62
    v_mfma_f32_16x16x32_bf16 a[32:35], v[200:203], v[128:131], a[32:35]
    v_add_f32 v12, v12, v60
    v_mfma_f32_16x16x32_bf16 a[32:35], v[204:207], v[144:147], a[32:35]
    v_exp_f32 v63, v63
    v_mfma_f32_16x16x32_bf16 a[36:39], v[192:195], v[84:87], a[36:39]
    buffer_load_dwordx4 v[168:171], v1, s[8:11], s29 offen offset:2048 sc1
    v_add_f32 v12, v12, v61
    v_mfma_f32_16x16x32_bf16 a[36:39], v[196:199], v[116:119], a[36:39]
    v_cvt_pk_bf16_f32 v108, v60, v61
    v_mfma_f32_16x16x32_bf16 a[36:39], v[200:203], v[132:135], a[36:39]
    v_exp_f32 v76, v76
    v_mfma_f32_16x16x32_bf16 a[36:39], v[204:207], v[148:151], a[36:39]
    v_add_f32 v12, v12, v62
    v_mfma_f32_16x16x32_bf16 a[40:43], v[192:195], v[88:91], a[40:43]
    buffer_load_dwordx4 v[172:175], v1, s[8:11], s29 offen offset:3072 sc1
    v_mfma_f32_16x16x32_bf16 a[40:43], v[196:199], v[120:123], a[40:43]
    v_exp_f32 v77, v77
    v_mfma_f32_16x16x32_bf16 a[40:43], v[200:203], v[136:139], a[40:43]
    v_add_f32 v12, v12, v63
    v_mfma_f32_16x16x32_bf16 a[40:43], v[204:207], v[152:155], a[40:43]
    v_cvt_pk_bf16_f32 v109, v62, v63
    v_mfma_f32_16x16x32_bf16 a[44:47], v[192:195], v[92:95], a[44:47]
    buffer_load_dwordx4 v[176:179], v2, s[8:11], s29 offen offset:0 sc1
    v_mfma_f32_16x16x32_bf16 a[44:47], v[196:199], v[124:127], a[44:47]
    v_exp_f32 v78, v78
    v_mfma_f32_16x16x32_bf16 a[44:47], v[200:203], v[140:143], a[44:47]
    v_add_f32 v12, v12, v76
    v_mfma_f32_16x16x32_bf16 a[44:47], v[204:207], v[156:159], a[44:47]
    s_waitcnt vmcnt(21)
    v_mfma_f32_16x16x32_bf16 a[48:51], v[208:211], v[80:83], a[48:51]
    buffer_load_dwordx4 v[180:183], v2, s[8:11], s29 offen offset:1024 sc1
    v_mfma_f32_16x16x32_bf16 a[48:51], v[212:215], v[112:115], a[48:51]
    v_exp_f32 v79, v79
    v_mfma_f32_16x16x32_bf16 a[48:51], v[216:219], v[128:131], a[48:51]
    v_add_f32 v12, v12, v77
    v_cvt_pk_bf16_f32 v110, v76, v77
    v_mfma_f32_16x16x32_bf16 a[48:51], v[220:223], v[144:147], a[48:51]
    s_nop 0
    v_add_f32 v12, v12, v78
    v_mfma_f32_16x16x32_bf16 a[52:55], v[208:211], v[84:87], a[52:55]
    buffer_load_dwordx4 v[184:187], v2, s[8:11], s29 offen offset:2048 sc1
    v_add_f32 v12, v12, v79
    v_mfma_f32_16x16x32_bf16 a[52:55], v[212:215], v[116:119], a[52:55]
    v_cvt_pk_bf16_f32 v111, v78, v79
    ds_write_b128 v5, v[108:111] offset:19456
    v_mfma_f32_16x16x32_bf16 a[52:55], v[216:219], v[132:135], a[52:55]
    v_mfma_f32_16x16x32_bf16 a[52:55], v[220:223], v[148:151], a[52:55]
    v_mfma_f32_16x16x32_bf16 a[56:59], v[208:211], v[88:91], a[56:59]
    buffer_load_dwordx4 v[188:191], v2, s[8:11], s29 offen offset:3072 sc1
    v_mfma_f32_16x16x32_bf16 a[56:59], v[212:215], v[120:123], a[56:59]
    v_mfma_f32_16x16x32_bf16 a[56:59], v[216:219], v[136:139], a[56:59]
    v_mfma_f32_16x16x32_bf16 a[56:59], v[220:223], v[152:155], a[56:59]
    v_mfma_f32_16x16x32_bf16 a[60:63], v[208:211], v[92:95], a[60:63]
    buffer_load_dwordx4 v[192:195], v3, s[8:11], s29 offen offset:0 sc1
    v_mfma_f32_16x16x32_bf16 a[60:63], v[212:215], v[124:127], a[60:63]
    v_mfma_f32_16x16x32_bf16 a[60:63], v[216:219], v[140:143], a[60:63]
    v_mfma_f32_16x16x32_bf16 a[60:63], v[220:223], v[156:159], a[60:63]
    s_add_u32 s30, s30, 1
    s_waitcnt lgkmcnt(0)
    s_barrier
    s_bitcmp1_b32 s38, s30
    s_cbranch_scc0 L_nohook_odd
    s_call_b64 s[66:67], L_hook
L_nohook_odd:
    s_waitcnt vmcnt(17)
    v_mfma_f32_16x16x32_bf16 v[48:51], a[192:195], a[64:67], 0
    buffer_load_dwordx4 v[196:199], v3, s[8:11], s29 offen offset:1024 sc1
    s_add_u32 s28, s30, 2
    v_mfma_f32_16x16x32_bf16 v[48:51], a[196:199], a[68:71], v[48:51]
    s_add_u32 s96, s28, s31
    s_and_b32 s96, s96, 3
    v_mfma_f32_16x16x32_bf16 v[48:51], a[200:203], a[72:75], v[48:51]
    s_and_b32 s28, s28, 12
    s_or_b32 s28, s28, s96
    v_mfma_f32_16x16x32_bf16 v[48:51], a[204:207], a[76:79], v[48:51]
    s_lshl_b32 s28, s28, 16
    s_cmp_lt_u32 s30, 14
    v_mfma_f32_16x16x32_bf16 v[48:51], a[208:211], a[80:83], v[48:51]
    buffer_load_dwordx4 v[200:203], v3, s[8:11], s29 offen offset:2048 sc1
    s_cselect_b32 s35, s28, 0x100000
    v_mfma_f32_16x16x32_bf16 v[48:51], a[212:215], a[84:87], v[48:51]
    ds_read_b128 v[112:115], v6 offset:16384
    v_mfma_f32_16x16x32_bf16 v[48:51], a[216:219], a[88:91], v[48:51]
    ds_read_b128 v[116:119], v6 offset:17408
    v_mfma_f32_16x16x32_bf16 v[48:51], a[220:223], a[92:95], v[48:51]
    ds_read_b128 v[120:123], v6 offset:18432
    v_mfma_f32_16x16x32_bf16 v[52:55], a[192:195], a[96:99], 0
    buffer_load_dwordx4 v[204:207], v3, s[8:11], s29 offen offset:3072 sc1
    ds_read_b128 v[124:127], v6 offset:19456
    v_mfma_f32_16x16x32_bf16 v[52:55], a[196:199], a[100:103], v[52:55]
    ds_read_b128 v[128:131], v7 offset:16384
    v_mfma_f32_16x16x32_bf16 v[52:55], a[200:203], a[104:107], v[52:55]
    ds_read_b128 v[132:135], v7 offset:17408
    v_mfma_f32_16x16x32_bf16 v[52:55], a[204:207], a[108:111], v[52:55]
    ds_read_b128 v[136:139], v7 offset:18432
    v_mfma_f32_16x16x32_bf16 v[52:55], a[208:211], a[112:115], v[52:55]
    buffer_load_dwordx4 v[208:211], v4, s[8:11], s29 offen offset:0 sc1
    ds_read_b128 v[140:143], v7 offset:19456
    v_mfma_f32_16x16x32_bf16 v[52:55], a[212:215], a[116:119], v[52:55]
    ds_read_b128 v[144:147], v8 offset:16384
    v_mfma_f32_16x16x32_bf16 v[52:55], a[216:219], a[120:123], v[52:55]
    ds_read_b128 v[148:151], v8 offset:17408
    v_mfma_f32_16x16x32_bf16 v[52:55], a[220:223], a[124:127], v[52:55]
    ds_read_b128 v[152:155], v8 offset:18432
    v_mfma_f32_16x16x32_bf16 v[56:59], a[192:195], a[128:131], 0
    buffer_load_dwordx4 v[212:215], v4, s[8:11], s29 offen offset:1024 sc1
    ds_read_b128 v[156:159], v8 offset:19456
    v_mfma_f32_16x16x32_bf16 v[56:59], a[196:199], a[132:135], v[56:59]
    v_exp_f32 v16, v16
    v_mfma_f32_16x16x32_bf16 v[56:59], a[200:203], a[136:139], v[56:59]
    v_exp_f32 v17, v17
    v_mfma_f32_16x16x32_bf16 v[56:59], a[204:207], a[140:143], v[56:59]
    v_exp_f32 v18, v18
    v_mfma_f32_16x16x32_bf16 v[56:59], a[208:211], a[144:147], v[56:59]
    buffer_load_dwordx4 v[216:219], v4, s[8:11], s29 offen offset:2048 sc1
    v_add_f32 v9, v9, v16
    v_mfma_f32_16x16x32_bf16 v[56:59], a[212:215], a[148:151], v[56:59]
    v_exp_f32 v19, v19
    v_mfma_f32_16x16x32_bf16 v[56:59], a[216:219], a[152:155], v[56:59]
    v_add_f32 v9, v9, v17
    v_cvt_pk_bf16_f32 v80, v16, v17
    v_mfma_f32_16x16x32_bf16 v[56:59], a[220:223], a[156:159], v[56:59]
    v_exp_f32 v32, v32
    v_mfma_f32_16x16x32_bf16 v[60:63], a[192:195], a[160:163], 0
    buffer_load_dwordx4 v[220:223], v4, s[8:11], s29 offen offset:3072 sc1
    v_add_f32 v9, v9, v18
    v_mfma_f32_16x16x32_bf16 v[60:63], a[196:199], a[164:167], v[60:63]
    v_exp_f32 v33, v33
    v_mfma_f32_16x16x32_bf16 v[60:63], a[200:203], a[168:171], v[60:63]
    v_add_f32 v9, v9, v19
    v_cvt_pk_bf16_f32 v81, v18, v19
    v_mfma_f32_16x16x32_bf16 v[60:63], a[204:207], a[172:175], v[60:63]
    v_mfma_f32_16x16x32_bf16 v[60:63], a[208:211], a[176:179], v[60:63]
    buffer_load_dwordx4 a[192:195], v1, s[4:7], s35 offen offset:0 sc1
    v_mfma_f32_16x16x32_bf16 v[60:63], a[212:215], a[180:183], v[60:63]
    v_exp_f32 v34, v34
    v_mfma_f32_16x16x32_bf16 v[60:63], a[216:219], a[184:187], v[60:63]
    v_add_f32 v9, v9, v32
    v_mfma_f32_16x16x32_bf16 v[60:63], a[220:223], a[188:191], v[60:63]
    s_waitcnt vmcnt(17)
    v_mfma_f32_16x16x32_bf16 v[64:67], a[224:227], a[64:67], 0
    buffer_load_dwordx4 a[196:199], v1, s[4:7], s35 offen offset:1024 sc1
    v_mfma_f32_16x16x32_bf16 v[64:67], a[228:231], a[68:71], v[64:67]
    v_exp_f32 v35, v35
    v_mfma_f32_16x16x32_bf16 v[64:67], a[232:235], a[72:75], v[64:67]
    v_add_f32 v9, v9, v33
    v_cvt_pk_bf16_f32 v82, v32, v33
    v_mfma_f32_16x16x32_bf16 v[64:67], a[236:239], a[76:79], v[64:67]
    v_exp_f32 v20, v20
    v_mfma_f32_16x16x32_bf16 v[64:67], a[240:243], a[80:83], v[64:67]
    buffer_load_dwordx4 a[200:203], v1, s[4:7], s35 offen offset:2048 sc1
    v_add_f32 v9, v9, v34
    v_mfma_f32_16x16x32_bf16 v[64:67], a[244:247], a[84:87], v[64:67]
    v_exp_f32 v21, v21
    v_mfma_f32_16x16x32_bf16 v[64:67], a[248:251], a[88:91], v[64:67]
    v_add_f32 v9, v9, v35
    v_mfma_f32_16x16x32_bf16 v[64:67], a[252:255], a[92:95], v[64:67]
    v_cvt_pk_bf16_f32 v83, v34, v35
    v_mfma_f32_16x16x32_bf16 v[68:71], a[224:227], a[96:99], 0
    buffer_load_dwordx4 a[204:207], v1, s[4:7], s35 offen offset:3072 sc1
    ds_write_b128 v5, v[80:83] offset:0
    v_mfma_f32_16x16x32_bf16 v[68:71], a[228:231], a[100:103], v[68:71]
    s_add_u32 s29, s30, 0
    v_mfma_f32_16x16x32_bf16 v[68:71], a[232:235], a[104:107], v[68:71]
    s_add_u32 s95, s29, s31
    v_mfma_f32_16x16x32_bf16 v[68:71], a[236:239], a[108:111], v[68:71]
    s_and_b32 s95, s95, 3
    v_mfma_f32_16x16x32_bf16 v[68:71], a[240:243], a[112:115], v[68:71]
    buffer_load_dwordx4 a[208:211], v2, s[4:7], s35 offen offset:0 sc1
    s_and_b32 s29, s29, 12
    v_mfma_f32_16x16x32_bf16 v[68:71], a[244:247], a[116:119], v[68:71]
    s_or_b32 s29, s29, s95
    v_mfma_f32_16x16x32_bf16 v[68:71], a[248:251], a[120:123], v[68:71]
    s_lshl_b32 s29, s29, 16
    v_mfma_f32_16x16x32_bf16 v[68:71], a[252:255], a[124:127], v[68:71]
    v_exp_f32 v22, v22
    v_mfma_f32_16x16x32_bf16 v[72:75], a[224:227], a[128:131], 0
    buffer_load_dwordx4 a[212:215], v2, s[4:7], s35 offen offset:1024 sc1
    v_add_f32 v10, v10, v20
    v_mfma_f32_16x16x32_bf16 v[72:75], a[228:231], a[132:135], v[72:75]
    v_exp_f32 v23, v23
    v_mfma_f32_16x16x32_bf16 v[72:75], a[232:235], a[136:139], v[72:75]
    v_add_f32 v10, v10, v21
    v_cvt_pk_bf16_f32 v84, v20, v21
    v_mfma_f32_16x16x32_bf16 v[72:75], a[236:239], a[140:143], v[72:75]
    v_exp_f32 v36, v36
    v_mfma_f32_16x16x32_bf16 v[72:75], a[240:243], a[144:147], v[72:75]
    buffer_load_dwordx4 a[216:219], v2, s[4:7], s35 offen offset:2048 sc1
    v_add_f32 v10, v10, v22
    v_mfma_f32_16x16x32_bf16 v[72:75], a[244:247], a[148:151], v[72:75]
    v_exp_f32 v37, v37
    v_mfma_f32_16x16x32_bf16 v[72:75], a[248:251], a[152:155], v[72:75]
    v_add_f32 v10, v10, v23
    v_mfma_f32_16x16x32_bf16 v[72:75], a[252:255], a[156:159], v[72:75]
    v_cvt_pk_bf16_f32 v85, v22, v23
    v_mfma_f32_16x16x32_bf16 v[76:79], a[224:227], a[160:163], 0
    buffer_load_dwordx4 a[220:223], v2, s[4:7], s35 offen offset:3072 sc1
    v_mfma_f32_16x16x32_bf16 v[76:79], a[228:231], a[164:167], v[76:79]
    v_exp_f32 v38, v38
    v_mfma_f32_16x16x32_bf16 v[76:79], a[232:235], a[168:171], v[76:79]
    v_add_f32 v10, v10, v36
    v_mfma_f32_16x16x32_bf16 v[76:79], a[236:239], a[172:175], v[76:79]
    v_exp_f32 v39, v39
    v_mfma_f32_16x16x32_bf16 v[76:79], a[240:243], a[176:179], v[76:79]
    buffer_load_dwordx4 a[224:227], v3, s[4:7], s35 offen offset:0 sc1
    v_add_f32 v10, v10, v37
    v_mfma_f32_16x16x32_bf16 v[76:79], a[244:247], a[180:183], v[76:79]
    v_cvt_pk_bf16_f32 v86, v36, v37
    v_mfma_f32_16x16x32_bf16 v[76:79], a[248:251], a[184:187], v[76:79]
    v_mfma_f32_16x16x32_bf16 v[76:79], a[252:255], a[188:191], v[76:79]
    s_waitcnt vmcnt(21)
    v_mfma_f32_16x16x32_bf16 a[0:3], v[160:163], v[96:99], a[0:3]
    buffer_load_dwordx4 a[228:231], v3, s[4:7], s35 offen offset:1024 sc1
    s_waitcnt lgkmcnt(1)
    v_mfma_f32_16x16x32_bf16 a[0:3], v[164:167], v[112:115], a[0:3]
    v_exp_f32 v24, v24
    v_mfma_f32_16x16x32_bf16 a[0:3], v[168:171], v[128:131], a[0:3]
    v_add_f32 v10, v10, v38
    v_mfma_f32_16x16x32_bf16 a[0:3], v[172:175], v[144:147], a[0:3]
    v_exp_f32 v25, v25
    v_mfma_f32_16x16x32_bf16 a[4:7], v[160:163], v[100:103], a[4:7]
    buffer_load_dwordx4 a[232:235], v3, s[4:7], s35 offen offset:2048 sc1
    v_add_f32 v10, v10, v39
    v_mfma_f32_16x16x32_bf16 a[4:7], v[164:167], v[116:119], a[4:7]
    v_cvt_pk_bf16_f32 v87, v38, v39
    ds_write_b128 v5, v[84:87] offset:1024
    v_mfma_f32_16x16x32_bf16 a[4:7], v[168:171], v[132:135], a[4:7]
    v_mfma_f32_16x16x32_bf16 a[4:7], v[172:175], v[148:151], a[4:7]
    v_exp_f32 v26, v26
    v_mfma_f32_16x16x32_bf16 a[8:11], v[160:163], v[104:107], a[8:11]
    buffer_load_dwordx4 a[236:239], v3, s[4:7], s35 offen offset:3072 sc1
    v_add_f32 v11, v11, v24
    v_mfma_f32_16x16x32_bf16 a[8:11], v[164:167], v[120:123], a[8:11]
    v_exp_f32 v27, v27
    v_mfma_f32_16x16x32_bf16 a[8:11], v[168:171], v[136:139], a[8:11]
    v_add_f32 v11, v11, v25
    v_mfma_f32_16x16x32_bf16 a[8:11], v[172:175], v[152:155], a[8:11]
    v_cvt_pk_bf16_f32 v88, v24, v25
    v_mfma_f32_16x16x32_bf16 a[12:15], v[160:163], v[108:111], a[12:15]
    buffer_load_dwordx4 a[240:243], v4, s[4:7], s35 offen offset:0 sc1
    v_mfma_f32_16x16x32_bf16 a[12:15], v[164:167], v[124:127], a[12:15]
    v_exp_f32 v40, v40
    v_mfma_f32_16x16x32_bf16 a[12:15], v[168:171], v[140:143], a[12:15]
    v_add_f32 v11, v11, v26
    v_mfma_f32_16x16x32_bf16 a[12:15], v[172:175], v[156:159], a[12:15]
    s_waitcnt vmcnt(21)
    v_mfma_f32_16x16x32_bf16 a[16:19], v[176:179], v[96:99], a[16:19]
    buffer_load_dwordx4 a[244:247], v4, s[4:7], s35 offen offset:1024 sc1
    v_mfma_f32_16x16x32_bf16 a[16:19], v[180:183], v[112:115], a[16:19]
    v_exp_f32 v41, v41
    v_mfma_f32_16x16x32_bf16 a[16:19], v[184:187], v[128:131], a[16:19]
    v_add_f32 v11, v11, v27
    v_cvt_pk_bf16_f32 v89, v26, v27
    v_mfma_f32_16x16x32_bf16 a[16:19], v[188:191], v[144:147], a[16:19]
    v_exp_f32 v42, v42
    v_mfma_f32_16x16x32_bf16 a[20:23], v[176:179], v[100:103], a[20:23]
    buffer_load_dwordx4 a[248:251], v4, s[4:7], s35 offen offset:2048 sc1
    v_add_f32 v11, v11, v40
    v_mfma_f32_16x16x32_bf16 a[20:23], v[180:183], v[116:119], a[20:23]
    v_mfma_f32_16x16x32_bf16 a[20:23], v[184:187], v[132:135], a[20:23]
    v_exp_f32 v43, v43
    v_mfma_f32_16x16x32_bf16 a[20:23], v[188:191], v[148:151], a[20:23]
    v_add_f32 v11, v11, v41
    v_cvt_pk_bf16_f32 v90, v40, v41
    v_mfma_f32_16x16x32_bf16 a[24:27], v[176:179], v[104:107], a[24:27]
    buffer_load_dwordx4 a[252:255], v4, s[4:7], s35 offen offset:3072 sc1
    v_mfma_f32_16x16x32_bf16 a[24:27], v[180:183], v[120:123], a[24:27]
    v_exp_f32 v28, v28
    v_mfma_f32_16x16x32_bf16 a[24:27], v[184:187], v[136:139], a[24:27]
    v_add_f32 v11, v11, v42
    v_mfma_f32_16x16x32_bf16 a[24:27], v[188:191], v[152:155], a[24:27]
    v_exp_f32 v29, v29
    v_mfma_f32_16x16x32_bf16 a[28:31], v[176:179], v[108:111], a[28:31]
    buffer_load_dwordx4 v[160:163], v1, s[8:11], s29 offen offset:0 sc1
    v_mfma_f32_16x16x32_bf16 a[28:31], v[180:183], v[124:127], a[28:31]
    v_add_f32 v11, v11, v43
    v_cvt_pk_bf16_f32 v91, v42, v43
    v_mfma_f32_16x16x32_bf16 a[28:31], v[184:187], v[140:143], a[28:31]
    ds_write_b128 v5, v[88:91] offset:2048
    v_mfma_f32_16x16x32_bf16 a[28:31], v[188:191], v[156:159], a[28:31]
    s_waitcnt vmcnt(21)
    v_mfma_f32_16x16x32_bf16 a[32:35], v[192:195], v[96:99], a[32:35]
    buffer_load_dwordx4 v[164:167], v1, s[8:11], s29 offen offset:1024 sc1
    v_mfma_f32_16x16x32_bf16 a[32:35], v[196:199], v[112:115], a[32:35]
    v_exp_f32 v30, v30
    v_mfma_f32_16x16x32_bf16 a[32:35], v[200:203], v[128:131], a[32:35]
    v_add_f32 v12, v12, v28
    v_mfma_f32_16x16x32_bf16 a[32:35], v[204:207], v[144:147], a[32:35]
    v_exp_f32 v31, v31
    v_mfma_f32_16x16x32_bf16 a[36:39], v[192:195], v[100:103], a[36:39]
    buffer_load_dwordx4 v[168:171], v1, s[8:11], s29 offen offset:2048 sc1
    v_add_f32 v12, v12, v29
    v_mfma_f32_16x16x32_bf16 a[36:39], v[196:199], v[116:119], a[36:39]
    v_cvt_pk_bf16_f32 v92, v28, v29
    v_mfma_f32_16x16x32_bf16 a[36:39], v[200:203], v[132:135], a[36:39]
    v_exp_f32 v44, v44
    v_mfma_f32_16x16x32_bf16 a[36:39], v[204:207], v[148:151], a[36:39]
    v_add_f32 v12, v12, v30
    v_mfma_f32_16x16x32_bf16 a[40:43], v[192:195], v[104:107], a[40:43]
    buffer_load_dwordx4 v[172:175], v1, s[8:11], s29 offen offset:3072 sc1
    v_mfma_f32_16x16x32_bf16 a[40:43], v[196:199], v[120:123], a[40:43]
    v_exp_f32 v45, v45
    v_mfma_f32_16x16x32_bf16 a[40:43], v[200:203], v[136:139], a[40:43]
    v_add_f32 v12, v12, v31
    v_mfma_f32_16x16x32_bf16 a[40:43], v[204:207], v[152:155], a[40:43]
    v_cvt_pk_bf16_f32 v93, v30, v31
    v_mfma_f32_16x16x32_bf16 a[44:47], v[192:195], v[108:111], a[44:47]
    buffer_load_dwordx4 v[176:179], v2, s[8:11], s29 offen offset:0 sc1
    v_mfma_f32_16x16x32_bf16 a[44:47], v[196:199], v[124:127], a[44:47]
    v_exp_f32 v46, v46
    v_mfma_f32_16x16x32_bf16 a[44:47], v[200:203], v[140:143], a[44:47]
    v_add_f32 v12, v12, v44
    v_mfma_f32_16x16x32_bf16 a[44:47], v[204:207], v[156:159], a[44:47]
    s_waitcnt vmcnt(21)
    v_mfma_f32_16x16x32_bf16 a[48:51], v[208:211], v[96:99], a[48:51]
    buffer_load_dwordx4 v[180:183], v2, s[8:11], s29 offen offset:1024 sc1
    v_mfma_f32_16x16x32_bf16 a[48:51], v[212:215], v[112:115], a[48:51]
    v_exp_f32 v47, v47
    v_mfma_f32_16x16x32_bf16 a[48:51], v[216:219], v[128:131], a[48:51]
    v_add_f32 v12, v12, v45
    v_cvt_pk_bf16_f32 v94, v44, v45
    v_mfma_f32_16x16x32_bf16 a[48:51], v[220:223], v[144:147], a[48:51]
    s_nop 0
    v_add_f32 v12, v12, v46
    v_mfma_f32_16x16x32_bf16 a[52:55], v[208:211], v[100:103], a[52:55]
    buffer_load_dwordx4 v[184:187], v2, s[8:11], s29 offen offset:2048 sc1
    v_add_f32 v12, v12, v47
    v_mfma_f32_16x16x32_bf16 a[52:55], v[212:215], v[116:119], a[52:55]
    v_cvt_pk_bf16_f32 v95, v46, v47
    ds_write_b128 v5, v[92:95] offset:3072
    v_mfma_f32_16x16x32_bf16 a[52:55], v[216:219], v[132:135], a[52:55]
    v_mfma_f32_16x16x32_bf16 a[52:55], v[220:223], v[148:151], a[52:55]
    v_mfma_f32_16x16x32_bf16 a[56:59], v[208:211], v[104:107], a[56:59]
    buffer_load_dwordx4 v[188:191], v2, s[8:11], s29 offen offset:3072 sc1
    v_mfma_f32_16x16x32_bf16 a[56:59], v[212:215], v[120:123], a[56:59]
    v_mfma_f32_16x16x32_bf16 a[56:59], v[216:219], v[136:139], a[56:59]
    v_mfma_f32_16x16x32_bf16 a[56:59], v[220:223], v[152:155], a[56:59]
    v_mfma_f32_16x16x32_bf16 a[60:63], v[208:211], v[108:111], a[60:63]
    buffer_load_dwordx4 v[192:195], v3, s[8:11], s29 offen offset:0 sc1
    v_mfma_f32_16x16x32_bf16 a[60:63], v[212:215], v[124:127], a[60:63]
    v_mfma_f32_16x16x32_bf16 a[60:63], v[216:219], v[140:143], a[60:63]
    v_mfma_f32_16x16x32_bf16 a[60:63], v[220:223], v[156:159], a[60:63]
    s_add_u32 s30, s30, 1
    s_waitcnt lgkmcnt(0)
    s_barrier
    s_bitcmp1_b32 s38, s30
    s_cbranch_scc0 L_nohook_even
    s_call_b64 s[66:67], L_hook
L_nohook_even:
    s_cmp_lt_u32 s30, 15
    s_cbranch_scc1 L_loop
    s_waitcnt vmcnt(5)
    v_mfma_f32_16x16x32_bf16 a[0:3], v[160:163], v[80:83], a[0:3]
    buffer_load_dwordx4 v[196:199], v3, s[8:11], s29 offen offset:1024 sc1
    buffer_load_dwordx4 v[200:203], v3, s[8:11], s29 offen offset:2048 sc1
    buffer_load_dwordx4 v[204:207], v3, s[8:11], s29 offen offset:3072 sc1
    buffer_load_dwordx4 v[208:211], v4, s[8:11], s29 offen offset:0 sc1
    buffer_load_dwordx4 v[212:215], v4, s[8:11], s29 offen offset:1024 sc1
    buffer_load_dwordx4 v[216:219], v4, s[8:11], s29 offen offset:2048 sc1
    buffer_load_dwordx4 v[220:223], v4, s[8:11], s29 offen offset:3072 sc1
    s_add_u32 s29, s30, 0
    s_add_u32 s95, s29, s31
    s_and_b32 s95, s95, 3
    s_and_b32 s29, s29, 12
    s_or_b32 s29, s29, s95
    s_lshl_b32 s29, s29, 16
    ds_read_b128 v[112:115], v6 offset:0
    ds_read_b128 v[116:119], v6 offset:1024
    ds_read_b128 v[120:123], v6 offset:2048
    ds_read_b128 v[124:127], v6 offset:3072
    ds_read_b128 v[128:131], v7 offset:0
    ds_read_b128 v[132:135], v7 offset:1024
    ds_read_b128 v[136:139], v7 offset:2048
    ds_read_b128 v[140:143], v7 offset:3072
    ds_read_b128 v[144:147], v8 offset:0
    ds_read_b128 v[148:151], v8 offset:1024
    ds_read_b128 v[152:155], v8 offset:2048
    ds_read_b128 v[156:159], v8 offset:3072
    s_waitcnt lgkmcnt(0)
    v_mfma_f32_16x16x32_bf16 a[0:3], v[164:167], v[112:115], a[0:3]
    v_exp_f32 v48, v48
    v_mfma_f32_16x16x32_bf16 a[0:3], v[168:171], v[128:131], a[0:3]
    v_exp_f32 v49, v49
    v_mfma_f32_16x16x32_bf16 a[0:3], v[172:175], v[144:147], a[0:3]
    v_exp_f32 v50, v50
    v_mfma_f32_16x16x32_bf16 a[4:7], v[160:163], v[84:87], a[4:7]
    v_add_f32 v9, v9, v48
    v_mfma_f32_16x16x32_bf16 a[4:7], v[164:167], v[116:119], a[4:7]
    v_exp_f32 v51, v51
    v_mfma_f32_16x16x32_bf16 a[4:7], v[168:171], v[132:135], a[4:7]
    v_add_f32 v9, v9, v49
    v_cvt_pk_bf16_f32 v96, v48, v49
    v_mfma_f32_16x16x32_bf16 a[4:7], v[172:175], v[148:151], a[4:7]
    v_exp_f32 v64, v64
    v_mfma_f32_16x16x32_bf16 a[8:11], v[160:163], v[88:91], a[8:11]
    v_add_f32 v9, v9, v50
    v_mfma_f32_16x16x32_bf16 a[8:11], v[164:167], v[120:123], a[8:11]
    v_exp_f32 v65, v65
    v_mfma_f32_16x16x32_bf16 a[8:11], v[168:171], v[136:139], a[8:11]
    v_add_f32 v9, v9, v51
    v_cvt_pk_bf16_f32 v97, v50, v51
    v_mfma_f32_16x16x32_bf16 a[8:11], v[172:175], v[152:155], a[8:11]
    v_exp_f32 v66, v66
    v_mfma_f32_16x16x32_bf16 a[12:15], v[160:163], v[92:95], a[12:15]
    buffer_load_dwordx4 v[160:163], v1, s[8:11], s29 offen offset:0 sc1
    v_add_f32 v9, v9, v64
    v_mfma_f32_16x16x32_bf16 a[12:15], v[164:167], v[124:127], a[12:15]
    buffer_load_dwordx4 v[164:167], v1, s[8:11], s29 offen offset:1024 sc1
    v_mfma_f32_16x16x32_bf16 a[12:15], v[168:171], v[140:143], a[12:15]
    buffer_load_dwordx4 v[168:171], v1, s[8:11], s29 offen offset:2048 sc1
    v_mfma_f32_16x16x32_bf16 a[12:15], v[172:175], v[156:159], a[12:15]
    buffer_load_dwordx4 v[172:175], v1, s[8:11], s29 offen offset:3072 sc1
    s_waitcnt vmcnt(12)
    v_mfma_f32_16x16x32_bf16 a[16:19], v[176:179], v[80:83], a[16:19]
    v_exp_f32 v67, v67
    v_mfma_f32_16x16x32_bf16 a[16:19], v[180:183], v[112:115], a[16:19]
    v_add_f32 v9, v9, v65
    v_cvt_pk_bf16_f32 v98, v64, v65
    v_mfma_f32_16x16x32_bf16 a[16:19], v[184:187], v[128:131], a[16:19]
    v_exp_f32 v52, v52
    v_mfma_f32_16x16x32_bf16 a[16:19], v[188:191], v[144:147], a[16:19]
    v_add_f32 v9, v9, v66
    v_mfma_f32_16x16x32_bf16 a[20:23], v[176:179], v[84:87], a[20:23]
    v_exp_f32 v53, v53
    v_mfma_f32_16x16x32_bf16 a[20:23], v[180:183], v[116:119], a[20:23]
    v_add_f32 v9, v9, v67
    v_cvt_pk_bf16_f32 v99, v66, v67
    v_mfma_f32_16x16x32_bf16 a[20:23], v[184:187], v[132:135], a[20:23]
    ds_write_b128 v5, v[96:99] offset:16384
    v_mfma_f32_16x16x32_bf16 a[20:23], v[188:191], v[148:151], a[20:23]
    v_exp_f32 v54, v54
    v_mfma_f32_16x16x32_bf16 a[24:27], v[176:179], v[88:91], a[24:27]
    v_add_f32 v10, v10, v52
    v_mfma_f32_16x16x32_bf16 a[24:27], v[180:183], v[120:123], a[24:27]
    v_exp_f32 v55, v55
    v_mfma_f32_16x16x32_bf16 a[24:27], v[184:187], v[136:139], a[24:27]
    v_add_f32 v10, v10, v53
    v_cvt_pk_bf16_f32 v100, v52, v53
    v_mfma_f32_16x16x32_bf16 a[24:27], v[188:191], v[152:155], a[24:27]
    v_exp_f32 v68, v68
    v_mfma_f32_16x16x32_bf16 a[28:31], v[176:179], v[92:95], a[28:31]
    buffer_load_dwordx4 v[176:179], v2, s[8:11], s29 offen offset:0 sc1
    v_add_f32 v10, v10, v54
    v_mfma_f32_16x16x32_bf16 a[28:31], v[180:183], v[124:127], a[28:31]
    buffer_load_dwordx4 v[180:183], v2, s[8:11], s29 offen offset:1024 sc1
    v_mfma_f32_16x16x32_bf16 a[28:31], v[184:187], v[140:143], a[28:31]
    buffer_load_dwordx4 v[184:187], v2, s[8:11], s29 offen offset:2048 sc1
    v_mfma_f32_16x16x32_bf16 a[28:31], v[188:191], v[156:159], a[28:31]
    buffer_load_dwordx4 v[188:191], v2, s[8:11], s29 offen offset:3072 sc1
    s_waitcnt vmcnt(12)
    v_mfma_f32_16x16x32_bf16 a[32:35], v[192:195], v[80:83], a[32:35]
    v_exp_f32 v69, v69
    v_mfma_f32_16x16x32_bf16 a[32:35], v[196:199], v[112:115], a[32:35]
    v_add_f32 v10, v10, v55
    v_cvt_pk_bf16_f32 v101, v54, v55
    v_mfma_f32_16x16x32_bf16 a[32:35], v[200:203], v[128:131], a[32:35]
    v_exp_f32 v70, v70
    v_mfma_f32_16x16x32_bf16 a[32:35], v[204:207], v[144:147], a[32:35]
    v_add_f32 v10, v10, v68
    v_mfma_f32_16x16x32_bf16 a[36:39], v[192:195], v[84:87], a[36:39]
    v_exp_f32 v71, v71
    v_mfma_f32_16x16x32_bf16 a[36:39], v[196:199], v[116:119], a[36:39]
    v_add_f32 v10, v10, v69
    v_cvt_pk_bf16_f32 v102, v68, v69
    v_mfma_f32_16x16x32_bf16 a[36:39], v[200:203], v[132:135], a[36:39]
    v_exp_f32 v56, v56
    v_mfma_f32_16x16x32_bf16 a[36:39], v[204:207], v[148:151], a[36:39]
    v_add_f32 v10, v10, v70
    v_mfma_f32_16x16x32_bf16 a[40:43], v[192:195], v[88:91], a[40:43]
    v_exp_f32 v57, v57
    v_mfma_f32_16x16x32_bf16 a[40:43], v[196:199], v[120:123], a[40:43]
    v_add_f32 v10, v10, v71
    v_cvt_pk_bf16_f32 v103, v70, v71
    v_mfma_f32_16x16x32_bf16 a[40:43], v[200:203], v[136:139], a[40:43]
    ds_write_b128 v5, v[100:103] offset:17408
    v_mfma_f32_16x16x32_bf16 a[40:43], v[204:207], v[152:155], a[40:43]
    v_exp_f32 v58, v58
    v_mfma_f32_16x16x32_bf16 a[44:47], v[192:195], v[92:95], a[44:47]
    buffer_load_dwordx4 v[192:195], v3, s[8:11], s29 offen offset:0 sc1
    v_add_f32 v11, v11, v56
    v_mfma_f32_16x16x32_bf16 a[44:47], v[196:199], v[124:127], a[44:47]
    buffer_load_dwordx4 v[196:199], v3, s[8:11], s29 offen offset:1024 sc1
    v_mfma_f32_16x16x32_bf16 a[44:47], v[200:203], v[140:143], a[44:47]
    buffer_load_dwordx4 v[200:203], v3, s[8:11], s29 offen offset:2048 sc1
    v_mfma_f32_16x16x32_bf16 a[44:47], v[204:207], v[156:159], a[44:47]
    buffer_load_dwordx4 v[204:207], v3, s[8:11], s29 offen offset:3072 sc1
    s_waitcnt vmcnt(12)
    v_mfma_f32_16x16x32_bf16 a[48:51], v[208:211], v[80:83], a[48:51]
    v_exp_f32 v59, v59
    v_mfma_f32_16x16x32_bf16 a[48:51], v[212:215], v[112:115], a[48:51]
    v_add_f32 v11, v11, v57
    v_cvt_pk_bf16_f32 v104, v56, v57
    v_mfma_f32_16x16x32_bf16 a[48:51], v[216:219], v[128:131], a[48:51]
    v_exp_f32 v72, v72
    v_mfma_f32_16x16x32_bf16 a[48:51], v[220:223], v[144:147], a[48:51]
    v_add_f32 v11, v11, v58
    v_mfma_f32_16x16x32_bf16 a[52:55], v[208:211], v[84:87], a[52:55]
    v_exp_f32 v73, v73
    v_mfma_f32_16x16x32_bf16 a[52:55], v[212:215], v[116:119], a[52:55]
    v_add_f32 v11, v11, v59
    v_cvt_pk_bf16_f32 v105, v58, v59
    v_mfma_f32_16x16x32_bf16 a[52:55], v[216:219], v[132:135], a[52:55]
    v_exp_f32 v74, v74
    v_mfma_f32_16x16x32_bf16 a[52:55], v[220:223], v[148:151], a[52:55]
    v_add_f32 v11, v11, v72
    v_mfma_f32_16x16x32_bf16 a[56:59], v[208:211], v[88:91], a[56:59]
    v_exp_f32 v75, v75
    v_mfma_f32_16x16x32_bf16 a[56:59], v[212:215], v[120:123], a[56:59]
    v_add_f32 v11, v11, v73
    v_cvt_pk_bf16_f32 v106, v72, v73
    v_mfma_f32_16x16x32_bf16 a[56:59], v[216:219], v[136:139], a[56:59]
    v_exp_f32 v60, v60
    v_mfma_f32_16x16x32_bf16 a[56:59], v[220:223], v[152:155], a[56:59]
    v_add_f32 v11, v11, v74
    v_mfma_f32_16x16x32_bf16 a[60:63], v[208:211], v[92:95], a[60:63]
    buffer_load_dwordx4 v[208:211], v4, s[8:11], s29 offen offset:0 sc1
    v_mfma_f32_16x16x32_bf16 a[60:63], v[212:215], v[124:127], a[60:63]
    buffer_load_dwordx4 v[212:215], v4, s[8:11], s29 offen offset:1024 sc1
    v_mfma_f32_16x16x32_bf16 a[60:63], v[216:219], v[140:143], a[60:63]
    buffer_load_dwordx4 v[216:219], v4, s[8:11], s29 offen offset:2048 sc1
    v_mfma_f32_16x16x32_bf16 a[60:63], v[220:223], v[156:159], a[60:63]
    buffer_load_dwordx4 v[220:223], v4, s[8:11], s29 offen offset:3072 sc1
    v_exp_f32 v61, v61
    v_add_f32 v11, v11, v75
    v_cvt_pk_bf16_f32 v107, v74, v75
    ds_write_b128 v5, v[104:107] offset:18432
    v_exp_f32 v62, v62
    v_add_f32 v12, v12, v60
    v_exp_f32 v63, v63
    v_add_f32 v12, v12, v61
    v_cvt_pk_bf16_f32 v108, v60, v61
    v_exp_f32 v76, v76
    v_add_f32 v12, v12, v62
    v_exp_f32 v77, v77
    v_add_f32 v12, v12, v63
    v_cvt_pk_bf16_f32 v109, v62, v63
    v_exp_f32 v78, v78
    v_add_f32 v12, v12, v76
    v_exp_f32 v79, v79
    v_add_f32 v12, v12, v77
    v_cvt_pk_bf16_f32 v110, v76, v77
    s_nop 0
    v_add_f32 v12, v12, v78
    v_add_f32 v12, v12, v79
    v_cvt_pk_bf16_f32 v111, v78, v79
    ds_write_b128 v5, v[108:111] offset:19456
    v_and_b32 v224, 15, v0
    v_lshrrev_b32 v225, 6, v0
    v_bfe_u32 v226, v0, 4, 2
    v_lshlrev_b32 v232, 4, v224
    v_add_u32 v232, 34816, v232
    v_lshl_add_u32 v231, v225, 2, v232
    v_lshlrev_b32 v233, 9, v224
    v_lshl_add_u32 v233, v225, 7, v233
    v_lshl_add_u32 v234, v226, 5, v233
    v_lshl_add_u32 v233, v226, 4, v233
    v_mov_b32 v240, v9
    v_mov_b32 v241, v10
    v_mov_b32 v242, v11
    v_mov_b32 v243, v12
    s_nop 1
    v_permlane32_swap_b32 v240, v9
    v_permlane32_swap_b32 v241, v10
    v_permlane32_swap_b32 v242, v11
    v_permlane32_swap_b32 v243, v12
    s_nop 1
    v_add_f32 v9, v9, v240
    v_add_f32 v10, v10, v241
    v_add_f32 v11, v11, v242
    v_add_f32 v12, v12, v243
    v_mov_b32 v240, v9
    v_mov_b32 v241, v10
    v_mov_b32 v242, v11
    v_mov_b32 v243, v12
    s_nop 1
    v_permlane16_swap_b32 v240, v9
    v_permlane16_swap_b32 v241, v10
    v_permlane16_swap_b32 v242, v11
    v_permlane16_swap_b32 v243, v12
    s_nop 1
    v_add_f32 v9, v9, v240
    v_add_f32 v10, v10, v241
    v_add_f32 v11, v11, v242
    v_add_f32 v12, v12, v243
    ds_write_b32 v231, v9 offset:0
    ds_write_b32 v231, v10 offset:256
    ds_write_b32 v231, v11 offset:512
    ds_write_b32 v231, v12 offset:768
    s_waitcnt lgkmcnt(0)
    s_barrier
    s_waitcnt vmcnt(12)
    v_mfma_f32_16x16x32_bf16 a[0:3], v[160:163], v[96:99], a[0:3]
    s_mov_b32 s92, 8192
    s_mov_b32 s93, 16384
    s_mov_b32 s94, 24576
    s_mov_b32 s95, 0x5d800000
    s_mov_b32 s96, 0x21800000
    ds_read_b128 v[112:115], v6 offset:16384
    ds_read_b128 v[116:119], v6 offset:17408
    ds_read_b128 v[120:123], v6 offset:18432
    ds_read_b128 v[124:127], v6 offset:19456
    ds_read_b128 v[128:131], v7 offset:16384
    ds_read_b128 v[132:135], v7 offset:17408
    ds_read_b128 v[136:139], v7 offset:18432
    ds_read_b128 v[140:143], v7 offset:19456
    ds_read_b128 v[144:147], v8 offset:16384
    ds_read_b128 v[148:151], v8 offset:17408
    ds_read_b128 v[152:155], v8 offset:18432
    ds_read_b128 v[156:159], v8 offset:19456
    ds_read_b128 v[240:243], v232 offset:0
    ds_read_b128 v[244:247], v232 offset:256
    ds_read_b128 v[248:251], v232 offset:512
    ds_read_b128 v[252:255], v232 offset:768
    s_waitcnt lgkmcnt(4)
    v_mfma_f32_16x16x32_bf16 a[0:3], v[164:167], v[112:115], a[0:3]
    v_mfma_f32_16x16x32_bf16 a[0:3], v[168:171], v[128:131], a[0:3]
    v_mfma_f32_16x16x32_bf16 a[0:3], v[172:175], v[144:147], a[0:3]
    s_waitcnt vmcnt(8)
    v_mfma_f32_16x16x32_bf16 a[16:19], v[176:179], v[96:99], a[16:19]
    s_waitcnt lgkmcnt(0)
    v_add_f32 v240, v240, v241
    v_mfma_f32_16x16x32_bf16 a[16:19], v[180:183], v[112:115], a[16:19]
    v_add_f32 v242, v242, v243
    v_add_f32 v244, v244, v245
    v_mfma_f32_16x16x32_bf16 a[16:19], v[184:187], v[128:131], a[16:19]
    v_add_f32 v246, v246, v247
    v_add_f32 v248, v248, v249
    v_mfma_f32_16x16x32_bf16 a[16:19], v[188:191], v[144:147], a[16:19]
    v_add_f32 v250, v250, v251
    v_add_f32 v252, v252, v253
    s_waitcnt vmcnt(4)
    v_mfma_f32_16x16x32_bf16 a[32:35], v[192:195], v[96:99], a[32:35]
    v_add_f32 v254, v254, v255
    v_add_f32 v240, v240, v242
    v_mfma_f32_16x16x32_bf16 a[32:35], v[196:199], v[112:115], a[32:35]
    v_add_f32 v244, v244, v246
    v_add_f32 v248, v248, v250
    v_mfma_f32_16x16x32_bf16 a[32:35], v[200:203], v[128:131], a[32:35]
    v_add_f32 v252, v252, v254
    v_max3_f32 v241, v240, v244, v248
    v_mfma_f32_16x16x32_bf16 a[32:35], v[204:207], v[144:147], a[32:35]
    v_min3_f32 v242, v240, v244, v248
    v_max_f32 v241, v241, v252
    s_waitcnt vmcnt(0)
    v_mfma_f32_16x16x32_bf16 a[48:51], v[208:211], v[96:99], a[48:51]
    v_min_f32 v242, v242, v252
    v_cmp_lt_f32 vcc, s95, v241
    v_mfma_f32_16x16x32_bf16 a[48:51], v[212:215], v[112:115], a[48:51]
    v_cmp_gt_f32 s[68:69], s96, v242
    v_rcp_f32 v240, v240
    v_mfma_f32_16x16x32_bf16 a[48:51], v[216:219], v[128:131], a[48:51]
    v_rcp_f32 v244, v244
    v_rcp_f32 v248, v248
    v_mfma_f32_16x16x32_bf16 a[48:51], v[220:223], v[144:147], a[48:51]
    v_rcp_f32 v252, v252
    s_or_b64 vcc, vcc, s[68:69]
    s_cbranch_vccnz L_slow
    v_mfma_f32_16x16x32_bf16 a[4:7], v[160:163], v[100:103], a[4:7]
    v_mfma_f32_16x16x32_bf16 a[4:7], v[164:167], v[116:119], a[4:7]
    v_mfma_f32_16x16x32_bf16 a[4:7], v[168:171], v[132:135], a[4:7]
    v_mfma_f32_16x16x32_bf16 a[4:7], v[172:175], v[148:151], a[4:7]
    v_accvgpr_read_b32 v48, a0
    v_accvgpr_read_b32 v49, a16
    v_accvgpr_read_b32 v52, a1
    v_accvgpr_read_b32 v53, a17
    v_mfma_f32_16x16x32_bf16 a[20:23], v[176:179], v[100:103], a[20:23]
    v_accvgpr_read_b32 v56, a2
    v_accvgpr_read_b32 v57, a18
    v_accvgpr_read_b32 v60, a3
    v_accvgpr_read_b32 v61, a19
    v_mfma_f32_16x16x32_bf16 a[20:23], v[180:183], v[116:119], a[20:23]
    v_accvgpr_read_b32 v50, a32
    v_accvgpr_read_b32 v51, a48
    v_accvgpr_read_b32 v54, a33
    v_accvgpr_read_b32 v55, a49
    v_mfma_f32_16x16x32_bf16 a[20:23], v[184:187], v[132:135], a[20:23]
    v_accvgpr_read_b32 v58, a34
    v_accvgpr_read_b32 v59, a50
    v_accvgpr_read_b32 v62, a35
    v_accvgpr_read_b32 v63, a51
    v_mfma_f32_16x16x32_bf16 a[20:23], v[188:191], v[148:151], a[20:23]
    v_pk_mul_f32 v[48:49], v[48:49], v[240:241] op_sel_hi:[1,0]
    v_pk_mul_f32 v[50:51], v[50:51], v[240:241] op_sel_hi:[1,0]
    v_pk_mul_f32 v[52:53], v[52:53], v[240:241] op_sel_hi:[1,0]
    v_pk_mul_f32 v[54:55], v[54:55], v[240:241] op_sel_hi:[1,0]
    v_mfma_f32_16x16x32_bf16 a[36:39], v[192:195], v[100:103], a[36:39]
    v_pk_mul_f32 v[56:57], v[56:57], v[240:241] op_sel_hi:[1,0]
    v_pk_mul_f32 v[58:59], v[58:59], v[240:241] op_sel_hi:[1,0]
    v_pk_mul_f32 v[60:61], v[60:61], v[240:241] op_sel_hi:[1,0]
    v_pk_mul_f32 v[62:63], v[62:63], v[240:241] op_sel_hi:[1,0]
    v_mfma_f32_16x16x32_bf16 a[36:39], v[196:199], v[116:119], a[36:39]
    v_cvt_pk_bf16_f32 v16, v48, v49
    v_cvt_pk_bf16_f32 v17, v50, v51
    v_cvt_pk_bf16_f32 v18, v52, v53
    v_cvt_pk_bf16_f32 v19, v54, v55
    v_mfma_f32_16x16x32_bf16 a[36:39], v[200:203], v[132:135], a[36:39]
    v_cvt_pk_bf16_f32 v20, v56, v57
    v_cvt_pk_bf16_f32 v21, v58, v59
    v_cvt_pk_bf16_f32 v22, v60, v61
    v_cvt_pk_bf16_f32 v23, v62, v63
    v_mfma_f32_16x16x32_bf16 a[36:39], v[204:207], v[148:151], a[36:39]
    s_nop 1
    v_permlane16_swap_b32 v16, v20
    v_permlane16_swap_b32 v17, v21
    v_permlane16_swap_b32 v18, v22
    v_mfma_f32_16x16x32_bf16 a[52:55], v[208:211], v[100:103], a[52:55]
    v_permlane16_swap_b32 v19, v23
    s_nop 1
    v_permlane32_swap_b32 v16, v20
    v_permlane32_swap_b32 v17, v21
    v_mfma_f32_16x16x32_bf16 a[52:55], v[212:215], v[116:119], a[52:55]
    v_permlane32_swap_b32 v18, v22
    v_permlane32_swap_b32 v19, v23
    s_nop 0
    buffer_store_dwordx4 v[16:19], v233, s[24:27], 0 offen sc1
    v_mfma_f32_16x16x32_bf16 a[52:55], v[216:219], v[132:135], a[52:55]
    buffer_store_dwordx4 v[20:23], v233, s[24:27], 0 offen offset:64 sc1
    v_mfma_f32_16x16x32_bf16 a[52:55], v[220:223], v[148:151], a[52:55]
    v_mfma_f32_16x16x32_bf16 a[8:11], v[160:163], v[104:107], a[8:11]
    v_mfma_f32_16x16x32_bf16 a[8:11], v[164:167], v[120:123], a[8:11]
    v_mfma_f32_16x16x32_bf16 a[8:11], v[168:171], v[136:139], a[8:11]
    v_mfma_f32_16x16x32_bf16 a[8:11], v[172:175], v[152:155], a[8:11]
    v_accvgpr_read_b32 v64, a4
    v_accvgpr_read_b32 v65, a20
    v_accvgpr_read_b32 v68, a5
    v_accvgpr_read_b32 v69, a21
    v_mfma_f32_16x16x32_bf16 a[24:27], v[176:179], v[104:107], a[24:27]
    v_accvgpr_read_b32 v72, a6
    v_accvgpr_read_b32 v73, a22
    v_accvgpr_read_b32 v76, a7
    v_accvgpr_read_b32 v77, a23
    v_mfma_f32_16x16x32_bf16 a[24:27], v[180:183], v[120:123], a[24:27]
    v_accvgpr_read_b32 v66, a36
    v_accvgpr_read_b32 v67, a52
    v_accvgpr_read_b32 v70, a37
    v_accvgpr_read_b32 v71, a53
    v_mfma_f32_16x16x32_bf16 a[24:27], v[184:187], v[136:139], a[24:27]
    v_accvgpr_read_b32 v74, a38
    v_accvgpr_read_b32 v75, a54
    v_accvgpr_read_b32 v78, a39
    v_accvgpr_read_b32 v79, a55
    v_mfma_f32_16x16x32_bf16 a[24:27], v[188:191], v[152:155], a[24:27]
    v_pk_mul_f32 v[64:65], v[64:65], v[244:245] op_sel_hi:[1,0]
    v_pk_mul_f32 v[66:67], v[66:67], v[244:245] op_sel_hi:[1,0]
    v_pk_mul_f32 v[68:69], v[68:69], v[244:245] op_sel_hi:[1,0]
    v_pk_mul_f32 v[70:71], v[70:71], v[244:245] op_sel_hi:[1,0]
    v_mfma_f32_16x16x32_bf16 a[40:43], v[192:195], v[104:107], a[40:43]
    v_pk_mul_f32 v[72:73], v[72:73], v[244:245] op_sel_hi:[1,0]
    v_pk_mul_f32 v[74:75], v[74:75], v[244:245] op_sel_hi:[1,0]
    v_pk_mul_f32 v[76:77], v[76:77], v[244:245] op_sel_hi:[1,0]
    v_pk_mul_f32 v[78:79], v[78:79], v[244:245] op_sel_hi:[1,0]
    v_mfma_f32_16x16x32_bf16 a[40:43], v[196:199], v[120:123], a[40:43]
    v_cvt_pk_bf16_f32 v24, v64, v65
    v_cvt_pk_bf16_f32 v25, v66, v67
    v_cvt_pk_bf16_f32 v26, v68, v69
    v_cvt_pk_bf16_f32 v27, v70, v71
    v_mfma_f32_16x16x32_bf16 a[40:43], v[200:203], v[136:139], a[40:43]
    v_cvt_pk_bf16_f32 v28, v72, v73
    v_cvt_pk_bf16_f32 v29, v74, v75
    v_cvt_pk_bf16_f32 v30, v76, v77
    v_cvt_pk_bf16_f32 v31, v78, v79
    v_mfma_f32_16x16x32_bf16 a[40:43], v[204:207], v[152:155], a[40:43]
    s_nop 1
    v_permlane16_swap_b32 v24, v28
    v_permlane16_swap_b32 v25, v29
    v_permlane16_swap_b32 v26, v30
    v_mfma_f32_16x16x32_bf16 a[56:59], v[208:211], v[104:107], a[56:59]
    v_permlane16_swap_b32 v27, v31
    s_nop 1
    v_permlane32_swap_b32 v24, v28
    v_permlane32_swap_b32 v25, v29
    v_mfma_f32_16x16x32_bf16 a[56:59], v[212:215], v[120:123], a[56:59]
    v_permlane32_swap_b32 v26, v30
    v_permlane32_swap_b32 v27, v31
    s_nop 0
    buffer_store_dwordx4 v[24:27], v233, s[24:27], s92 offen sc1
    v_mfma_f32_16x16x32_bf16 a[56:59], v[216:219], v[136:139], a[56:59]
    buffer_store_dwordx4 v[28:31], v233, s[24:27], s92 offen offset:64 sc1
    v_mfma_f32_16x16x32_bf16 a[56:59], v[220:223], v[152:155], a[56:59]
    v_mfma_f32_16x16x32_bf16 a[12:15], v[160:163], v[108:111], a[12:15]
    v_mfma_f32_16x16x32_bf16 a[12:15], v[164:167], v[124:127], a[12:15]
    v_mfma_f32_16x16x32_bf16 a[12:15], v[168:171], v[140:143], a[12:15]
    v_mfma_f32_16x16x32_bf16 a[12:15], v[172:175], v[156:159], a[12:15]
    v_accvgpr_read_b32 v48, a8
    v_accvgpr_read_b32 v49, a24
    v_accvgpr_read_b32 v52, a9
    v_accvgpr_read_b32 v53, a25
    v_mfma_f32_16x16x32_bf16 a[28:31], v[176:179], v[108:111], a[28:31]
    v_accvgpr_read_b32 v56, a10
    v_accvgpr_read_b32 v57, a26
    v_accvgpr_read_b32 v60, a11
    v_accvgpr_read_b32 v61, a27
    v_mfma_f32_16x16x32_bf16 a[28:31], v[180:183], v[124:127], a[28:31]
    v_accvgpr_read_b32 v50, a40
    v_accvgpr_read_b32 v51, a56
    v_accvgpr_read_b32 v54, a41
    v_accvgpr_read_b32 v55, a57
    v_mfma_f32_16x16x32_bf16 a[28:31], v[184:187], v[140:143], a[28:31]
    v_accvgpr_read_b32 v58, a42
    v_accvgpr_read_b32 v59, a58
    v_accvgpr_read_b32 v62, a43
    v_accvgpr_read_b32 v63, a59
    v_mfma_f32_16x16x32_bf16 a[28:31], v[188:191], v[156:159], a[28:31]
    v_pk_mul_f32 v[48:49], v[48:49], v[248:249] op_sel_hi:[1,0]
    v_pk_mul_f32 v[50:51], v[50:51], v[248:249] op_sel_hi:[1,0]
    v_pk_mul_f32 v[52:53], v[52:53], v[248:249] op_sel_hi:[1,0]
    v_pk_mul_f32 v[54:55], v[54:55], v[248:249] op_sel_hi:[1,0]
    v_mfma_f32_16x16x32_bf16 a[44:47], v[192:195], v[108:111], a[44:47]
    v_pk_mul_f32 v[56:57], v[56:57], v[248:249] op_sel_hi:[1,0]
    v_pk_mul_f32 v[58:59], v[58:59], v[248:249] op_sel_hi:[1,0]
    v_pk_mul_f32 v[60:61], v[60:61], v[248:249] op_sel_hi:[1,0]
    v_pk_mul_f32 v[62:63], v[62:63], v[248:249] op_sel_hi:[1,0]
    v_mfma_f32_16x16x32_bf16 a[44:47], v[196:199], v[124:127], a[44:47]
    v_cvt_pk_bf16_f32 v32, v48, v49
    v_cvt_pk_bf16_f32 v33, v50, v51
    v_cvt_pk_bf16_f32 v34, v52, v53
    v_cvt_pk_bf16_f32 v35, v54, v55
    v_mfma_f32_16x16x32_bf16 a[44:47], v[200:203], v[140:143], a[44:47]
    v_cvt_pk_bf16_f32 v36, v56, v57
    v_cvt_pk_bf16_f32 v37, v58, v59
    v_cvt_pk_bf16_f32 v38, v60, v61
    v_cvt_pk_bf16_f32 v39, v62, v63
    v_mfma_f32_16x16x32_bf16 a[44:47], v[204:207], v[156:159], a[44:47]
    s_nop 1
    v_permlane16_swap_b32 v32, v36
    v_permlane16_swap_b32 v33, v37
    v_permlane16_swap_b32 v34, v38
    v_mfma_f32_16x16x32_bf16 a[60:63], v[208:211], v[108:111], a[60:63]
    v_permlane16_swap_b32 v35, v39
    s_nop 1
    v_permlane32_swap_b32 v32, v36
    v_permlane32_swap_b32 v33, v37
    v_mfma_f32_16x16x32_bf16 a[60:63], v[212:215], v[124:127], a[60:63]
    v_permlane32_swap_b32 v34, v38
    v_permlane32_swap_b32 v35, v39
    s_nop 0
    buffer_store_dwordx4 v[32:35], v233, s[24:27], s93 offen sc1
    v_mfma_f32_16x16x32_bf16 a[60:63], v[216:219], v[140:143], a[60:63]
    buffer_store_dwordx4 v[36:39], v233, s[24:27], s93 offen offset:64 sc1
    v_mfma_f32_16x16x32_bf16 a[60:63], v[220:223], v[156:159], a[60:63]
    s_nop 7
    v_accvgpr_read_b32 v64, a12
    v_accvgpr_read_b32 v65, a28
    v_accvgpr_read_b32 v68, a13
    v_accvgpr_read_b32 v69, a29
    v_accvgpr_read_b32 v72, a14
    v_accvgpr_read_b32 v73, a30
    v_accvgpr_read_b32 v76, a15
    v_accvgpr_read_b32 v77, a31
    v_accvgpr_read_b32 v66, a44
    v_accvgpr_read_b32 v67, a60
    v_accvgpr_read_b32 v70, a45
    v_accvgpr_read_b32 v71, a61
    v_accvgpr_read_b32 v74, a46
    v_accvgpr_read_b32 v75, a62
    v_accvgpr_read_b32 v78, a47
    v_accvgpr_read_b32 v79, a63
    v_pk_mul_f32 v[64:65], v[64:65], v[252:253] op_sel_hi:[1,0]
    v_pk_mul_f32 v[66:67], v[66:67], v[252:253] op_sel_hi:[1,0]
    v_pk_mul_f32 v[68:69], v[68:69], v[252:253] op_sel_hi:[1,0]
    v_pk_mul_f32 v[70:71], v[70:71], v[252:253] op_sel_hi:[1,0]
    v_pk_mul_f32 v[72:73], v[72:73], v[252:253] op_sel_hi:[1,0]
    v_pk_mul_f32 v[74:75], v[74:75], v[252:253] op_sel_hi:[1,0]
    v_pk_mul_f32 v[76:77], v[76:77], v[252:253] op_sel_hi:[1,0]
    v_pk_mul_f32 v[78:79], v[78:79], v[252:253] op_sel_hi:[1,0]
    v_cvt_pk_bf16_f32 v40, v64, v65
    v_cvt_pk_bf16_f32 v41, v66, v67
    v_cvt_pk_bf16_f32 v42, v68, v69
    v_cvt_pk_bf16_f32 v43, v70, v71
    v_cvt_pk_bf16_f32 v44, v72, v73
    v_cvt_pk_bf16_f32 v45, v74, v75
    v_cvt_pk_bf16_f32 v46, v76, v77
    v_cvt_pk_bf16_f32 v47, v78, v79
    s_nop 1
    v_permlane16_swap_b32 v40, v44
    v_permlane16_swap_b32 v41, v45
    v_permlane16_swap_b32 v42, v46
    v_permlane16_swap_b32 v43, v47
    s_nop 1
    v_permlane32_swap_b32 v40, v44
    v_permlane32_swap_b32 v41, v45
    v_permlane32_swap_b32 v42, v46
    v_permlane32_swap_b32 v43, v47
    s_nop 0
    buffer_store_dwordx4 v[40:43], v233, s[24:27], s94 offen sc1
    buffer_store_dwordx4 v[44:47], v233, s[24:27], s94 offen offset:64 sc1
    s_endpgm
L_hook:
    s_and_b32 s92, s30, 7
    s_cmp_lg_u32 s92, 2
    s_cbranch_scc1 L_hook_d
    s_lshr_b32 s92, s30, 3
    s_add_u32 s92, s92, 3
    s_add_u32 s91, s39, s92
    s_sub_u32 s53, 4, s92
    s_waitcnt vmcnt(17)
    v_subrev_u32 v13, s91, v13
    v_cmp_lt_u32 vcc, s53, v13
    s_nop 4
    s_cbranch_vccz L_hook_d
    s_mov_b32 s97, 0
L_spin_hk:
    global_load_dword v13, v14, s[50:51] sc1
    s_waitcnt vmcnt(0)
    v_subrev_u32 v13, s91, v13
    v_cmp_lt_u32 vcc, s53, v13
    s_add_u32 s97, s97, 1
    s_cmp_lt_u32 s97, 0x8000
    s_cbranch_scc0 L_spin_hk_done
    s_nop 3
    s_cbranch_vccnz L_spin_hk
L_spin_hk_done:
L_hook_d:
    s_sub_u32 s95, s30, s64
    s_cmp_eq_u32 s95, 1
    s_cbranch_scc1 L_h_issue
    s_cmp_eq_u32 s95, 2
    s_cbranch_scc1 L_h_comp
    s_cmp_eq_u32 s95, 3
    s_cbranch_scc0 L_hook_ret
    s_cmp_lg_u32 s33, 0
    s_cbranch_scc1 L_pub4
    s_mov_b64 exec, 1
    s_add_u32 s93, s39, 4
    v_mov_b32 v158, s93
    s_lshl_b32 s92, s99, 5
    s_add_u32 s92, s92, s90
    s_lshl_b32 s92, s92, 7
    v_mov_b32 v159, s92
    global_store_dword v159, v158, s[50:51] sc1
    s_mov_b64 exec, -1
L_pub4:
    s_branch L_hook_ret
L_h_issue:
    s_cmp_lt_u32 s33, 2
    s_cbranch_scc1 L_h_issueV
    v_and_b32 v140, 7, v0
    v_bfe_u32 v156, v0, 3, 3
    v_lshlrev_b32 v158, 10, v156
    v_lshl_add_u32 v158, v140, 5, v158
    v_lshrrev_b32 v141, 2, v140
    v_lshlrev_b32 v157, 10, v141
    v_and_b32 v141, 3, v140
    v_lshl_add_u32 v157, v141, 8, v157
    v_lshl_add_u32 v157, v156, 4, v157
    s_lshl_b32 s92, s46, 10
    buffer_load_dwordx4 v[224:227], v158, s[56:59], s92 offen offset:0
    buffer_load_dwordx4 v[228:231], v158, s[56:59], s92 offen offset:16
    buffer_load_dwordx4 v[232:235], v158, s[56:59], s92 offen offset:256
    buffer_load_dwordx4 v[236:239], v158, s[56:59], s92 offen offset:272
    buffer_load_dwordx4 v[240:243], v158, s[56:59], s92 offen offset:512
    buffer_load_dwordx4 v[244:247], v158, s[56:59], s92 offen offset:528
    buffer_load_dwordx4 v[248:251], v158, s[56:59], s92 offen offset:768
    buffer_load_dwordx4 v[252:255], v158, s[56:59], s92 offen offset:784
    s_branch L_hook_ret
L_h_issueV:
    v_and_b32 v140, 15, v0
    v_bfe_u32 v141, v0, 4, 2
    v_lshlrev_b32 v158, 12, v141
    v_lshl_add_u32 v158, v140, 4, v158
    v_and_b32 v157, 63, v0
    v_lshlrev_b32 v157, 4, v157
    s_lshl_b32 s92, s47, 15
    s_lshl_b32 s93, s48, 8
    s_add_u32 s92, s92, s93
    s_add_u32 s93, s92, 16384
    buffer_load_dwordx4 v[224:227], v158, s[60:63], s92 offen offset:0
    buffer_load_dwordx4 v[228:231], v158, s[60:63], s92 offen offset:1024
    buffer_load_dwordx4 v[232:235], v158, s[60:63], s92 offen offset:2048
    buffer_load_dwordx4 v[236:239], v158, s[60:63], s92 offen offset:3072
    buffer_load_dwordx4 v[240:243], v158, s[60:63], s93 offen offset:0
    buffer_load_dwordx4 v[244:247], v158, s[60:63], s93 offen offset:1024
    buffer_load_dwordx4 v[248:251], v158, s[60:63], s93 offen offset:2048
    buffer_load_dwordx4 v[252:255], v158, s[60:63], s93 offen offset:3072
    s_branch L_hook_ret
L_h_comp:
    v_and_b32 v142, 63, v0
    v_lshlrev_b32 v143, 4, v142
    s_mul_i32 s93, s33, 2560
    s_add_u32 s93, s93, 35840
    v_add_u32 v142, s93, v143
    s_cmp_lt_u32 s33, 2
    s_cbranch_scc1 L_h_compV
    ds_read_b128 v[112:115], v143 offset:46080
    ds_read_b128 v[116:119], v143 offset:47104
    ds_read_b128 v[120:123], v143 offset:48128
    ds_read_b128 v[124:127], v143 offset:49152
    ds_read_b64 v[128:129], v142
    v_and_b32 v140, 7, v0
    v_bfe_u32 v156, v0, 3, 3
    v_lshlrev_b32 v158, 10, v156
    v_lshl_add_u32 v158, v140, 5, v158
    v_lshrrev_b32 v141, 2, v140
    v_lshlrev_b32 v157, 10, v141
    v_and_b32 v141, 3, v140
    v_lshl_add_u32 v157, v141, 8, v157
    v_lshl_add_u32 v157, v156, 4, v157
    s_waitcnt lgkmcnt(0)
    v_lshlrev_b32 v128, 16, v128
    v_lshlrev_b32 v129, 16, v129
    v_cvt_f32_u32 v130, v156
    v_cvt_f32_u32 v131, s46
    v_mul_f32 v129, v129, v128
    v_add_f32 v130, v130, v131
    v_cvt_f32_i32 v224, v224
    v_cvt_f32_i32 v225, v225
    v_cvt_f32_i32 v226, v226
    v_cvt_f32_i32 v227, v227
    v_cvt_f32_i32 v228, v228
    v_cvt_f32_i32 v229, v229
    v_cvt_f32_i32 v230, v230
    v_cvt_f32_i32 v231, v231
    v_cvt_f32_i32 v232, v232
    v_cvt_f32_i32 v233, v233
    v_cvt_f32_i32 v234, v234
    v_cvt_f32_i32 v235, v235
    v_cvt_f32_i32 v236, v236
    v_cvt_f32_i32 v237, v237
    v_cvt_f32_i32 v238, v238
    v_cvt_f32_i32 v239, v239
    v_cvt_f32_i32 v240, v240
    v_cvt_f32_i32 v241, v241
    v_cvt_f32_i32 v242, v242
    v_cvt_f32_i32 v243, v243
    v_cvt_f32_i32 v244, v244
    v_cvt_f32_i32 v245, v245
    v_cvt_f32_i32 v246, v246
    v_cvt_f32_i32 v247, v247
    v_cvt_f32_i32 v248, v248
    v_cvt_f32_i32 v249, v249
    v_cvt_f32_i32 v250, v250
    v_cvt_f32_i32 v251, v251
    v_cvt_f32_i32 v252, v252
    v_cvt_f32_i32 v253, v253
    v_cvt_f32_i32 v254, v254
    v_cvt_f32_i32 v255, v255
    v_pk_mul_f32 v[140:141], v[112:113], v[130:131] op_sel_hi:[1,0]
    v_pk_mul_f32 v[142:143], v[114:115], v[130:131] op_sel_hi:[1,0]
    v_pk_mul_f32 v[144:145], v[116:117], v[130:131] op_sel_hi:[1,0]
    v_pk_mul_f32 v[146:147], v[118:119], v[130:131] op_sel_hi:[1,0]
    v_fract_f32 v140, v140
    v_fract_f32 v141, v141
    v_fract_f32 v142, v142
    v_fract_f32 v143, v143
    v_fract_f32 v144, v144
    v_fract_f32 v145, v145
    v_fract_f32 v146, v146
    v_fract_f32 v147, v147
    v_cos_f32 v132, v140
    v_cos_f32 v133, v141
    v_cos_f32 v134, v142
    v_cos_f32 v135, v143
    v_cos_f32 v136, v144
    v_cos_f32 v137, v145
    v_cos_f32 v138, v146
    v_cos_f32 v139, v147
    v_sin_f32 v140, v140
    v_sin_f32 v141, v141
    v_sin_f32 v142, v142
    v_sin_f32 v143, v143
    v_sin_f32 v144, v144
    v_sin_f32 v145, v145
    v_sin_f32 v146, v146
    v_sin_f32 v147, v147
    v_pk_fma_f32 v[224:225], v[224:225], v[128:129], v[128:129] op_sel:[0,0,1] op_sel_hi:[1,0,1] neg_lo:[0,0,1] neg_hi:[0,0,1]
    v_pk_fma_f32 v[226:227], v[226:227], v[128:129], v[128:129] op_sel:[0,0,1] op_sel_hi:[1,0,1] neg_lo:[0,0,1] neg_hi:[0,0,1]
    v_pk_fma_f32 v[228:229], v[228:229], v[128:129], v[128:129] op_sel:[0,0,1] op_sel_hi:[1,0,1] neg_lo:[0,0,1] neg_hi:[0,0,1]
    v_pk_fma_f32 v[230:231], v[230:231], v[128:129], v[128:129] op_sel:[0,0,1] op_sel_hi:[1,0,1] neg_lo:[0,0,1] neg_hi:[0,0,1]
    v_pk_fma_f32 v[232:233], v[232:233], v[128:129], v[128:129] op_sel:[0,0,1] op_sel_hi:[1,0,1] neg_lo:[0,0,1] neg_hi:[0,0,1]
    v_pk_fma_f32 v[234:235], v[234:235], v[128:129], v[128:129] op_sel:[0,0,1] op_sel_hi:[1,0,1] neg_lo:[0,0,1] neg_hi:[0,0,1]
    v_pk_fma_f32 v[236:237], v[236:237], v[128:129], v[128:129] op_sel:[0,0,1] op_sel_hi:[1,0,1] neg_lo:[0,0,1] neg_hi:[0,0,1]
    v_pk_fma_f32 v[238:239], v[238:239], v[128:129], v[128:129] op_sel:[0,0,1] op_sel_hi:[1,0,1] neg_lo:[0,0,1] neg_hi:[0,0,1]
    v_pk_fma_f32 v[240:241], v[240:241], v[128:129], v[128:129] op_sel:[0,0,1] op_sel_hi:[1,0,1] neg_lo:[0,0,1] neg_hi:[0,0,1]
    v_pk_fma_f32 v[242:243], v[242:243], v[128:129], v[128:129] op_sel:[0,0,1] op_sel_hi:[1,0,1] neg_lo:[0,0,1] neg_hi:[0,0,1]
    v_pk_fma_f32 v[244:245], v[244:245], v[128:129], v[128:129] op_sel:[0,0,1] op_sel_hi:[1,0,1] neg_lo:[0,0,1] neg_hi:[0,0,1]
    v_pk_fma_f32 v[246:247], v[246:247], v[128:129], v[128:129] op_sel:[0,0,1] op_sel_hi:[1,0,1] neg_lo:[0,0,1] neg_hi:[0,0,1]
    v_pk_fma_f32 v[248:249], v[248:249], v[128:129], v[128:129] op_sel:[0,0,1] op_sel_hi:[1,0,1] neg_lo:[0,0,1] neg_hi:[0,0,1]
    v_pk_fma_f32 v[250:251], v[250:251], v[128:129], v[128:129] op_sel:[0,0,1] op_sel_hi:[1,0,1] neg_lo:[0,0,1] neg_hi:[0,0,1]
    v_pk_fma_f32 v[252:253], v[252:253], v[128:129], v[128:129] op_sel:[0,0,1] op_sel_hi:[1,0,1] neg_lo:[0,0,1] neg_hi:[0,0,1]
    v_pk_fma_f32 v[254:255], v[254:255], v[128:129], v[128:129] op_sel:[0,0,1] op_sel_hi:[1,0,1] neg_lo:[0,0,1] neg_hi:[0,0,1]
    v_pk_mul_f32 v[148:149], v[240:241], v[140:141]
    v_pk_mul_f32 v[150:151], v[242:243], v[142:143]
    v_pk_mul_f32 v[152:153], v[244:245], v[144:145]
    v_pk_mul_f32 v[154:155], v[246:247], v[146:147]
    v_pk_mul_f32 v[140:141], v[224:225], v[140:141]
    v_pk_mul_f32 v[142:143], v[226:227], v[142:143]
    v_pk_mul_f32 v[144:145], v[228:229], v[144:145]
    v_pk_mul_f32 v[146:147], v[230:231], v[146:147]
    v_pk_fma_f32 v[148:149], v[224:225], v[132:133], v[148:149] neg_lo:[0,0,1] neg_hi:[0,0,1]
    v_pk_fma_f32 v[150:151], v[226:227], v[134:135], v[150:151] neg_lo:[0,0,1] neg_hi:[0,0,1]
    v_pk_fma_f32 v[152:153], v[228:229], v[136:137], v[152:153] neg_lo:[0,0,1] neg_hi:[0,0,1]
    v_pk_fma_f32 v[154:155], v[230:231], v[138:139], v[154:155] neg_lo:[0,0,1] neg_hi:[0,0,1]
    v_pk_fma_f32 v[140:141], v[240:241], v[132:133], v[140:141]
    v_pk_fma_f32 v[142:143], v[242:243], v[134:135], v[142:143]
    v_pk_fma_f32 v[144:145], v[244:245], v[136:137], v[144:145]
    v_pk_fma_f32 v[146:147], v[246:247], v[138:139], v[146:147]
    v_cvt_pk_bf16_f32 v224, v148, v149
    v_cvt_pk_bf16_f32 v225, v150, v151
    v_cvt_pk_bf16_f32 v226, v152, v153
    v_cvt_pk_bf16_f32 v227, v154, v155
    v_cvt_pk_bf16_f32 v240, v140, v141
    v_cvt_pk_bf16_f32 v241, v142, v143
    v_cvt_pk_bf16_f32 v242, v144, v145
    v_cvt_pk_bf16_f32 v243, v146, v147
    v_pk_mul_f32 v[140:141], v[120:121], v[130:131] op_sel_hi:[1,0]
    v_pk_mul_f32 v[142:143], v[122:123], v[130:131] op_sel_hi:[1,0]
    v_pk_mul_f32 v[144:145], v[124:125], v[130:131] op_sel_hi:[1,0]
    v_pk_mul_f32 v[146:147], v[126:127], v[130:131] op_sel_hi:[1,0]
    v_fract_f32 v140, v140
    v_fract_f32 v141, v141
    v_fract_f32 v142, v142
    v_fract_f32 v143, v143
    v_fract_f32 v144, v144
    v_fract_f32 v145, v145
    v_fract_f32 v146, v146
    v_fract_f32 v147, v147
    v_cos_f32 v132, v140
    v_cos_f32 v133, v141
    v_cos_f32 v134, v142
    v_cos_f32 v135, v143
    v_cos_f32 v136, v144
    v_cos_f32 v137, v145
    v_cos_f32 v138, v146
    v_cos_f32 v139, v147
    v_sin_f32 v140, v140
    v_sin_f32 v141, v141
    v_sin_f32 v142, v142
    v_sin_f32 v143, v143
    v_sin_f32 v144, v144
    v_sin_f32 v145, v145
    v_sin_f32 v146, v146
    v_sin_f32 v147, v147
    s_nop 0
    v_pk_mul_f32 v[148:149], v[248:249], v[140:141]
    v_pk_mul_f32 v[150:151], v[250:251], v[142:143]
    v_pk_mul_f32 v[152:153], v[252:253], v[144:145]
    v_pk_mul_f32 v[154:155], v[254:255], v[146:147]
    v_pk_mul_f32 v[140:141], v[232:233], v[140:141]
    v_pk_mul_f32 v[142:143], v[234:235], v[142:143]
    v_pk_mul_f32 v[144:145], v[236:237], v[144:145]
    v_pk_mul_f32 v[146:147], v[238:239], v[146:147]
    v_pk_fma_f32 v[148:149], v[232:233], v[132:133], v[148:149] neg_lo:[0,0,1] neg_hi:[0,0,1]
    v_pk_fma_f32 v[150:151], v[234:235], v[134:135], v[150:151] neg_lo:[0,0,1] neg_hi:[0,0,1]
    v_pk_fma_f32 v[152:153], v[236:237], v[136:137], v[152:153] neg_lo:[0,0,1] neg_hi:[0,0,1]
    v_pk_fma_f32 v[154:155], v[238:239], v[138:139], v[154:155] neg_lo:[0,0,1] neg_hi:[0,0,1]
    v_pk_fma_f32 v[140:141], v[248:249], v[132:133], v[140:141]
    v_pk_fma_f32 v[142:143], v[250:251], v[134:135], v[142:143]
    v_pk_fma_f32 v[144:145], v[252:253], v[136:137], v[144:145]
    v_pk_fma_f32 v[146:147], v[254:255], v[138:139], v[146:147]
    v_cvt_pk_bf16_f32 v232, v148, v149
    v_cvt_pk_bf16_f32 v233, v150, v151
    v_cvt_pk_bf16_f32 v234, v152, v153
    v_cvt_pk_bf16_f32 v235, v154, v155
    v_cvt_pk_bf16_f32 v248, v140, v141
    v_cvt_pk_bf16_f32 v249, v142, v143
    v_cvt_pk_bf16_f32 v250, v144, v145
    v_cvt_pk_bf16_f32 v251, v146, v147
    s_lshr_b32 s92, s46, 4
    s_lshl_b32 s92, s92, 13
    s_and_b32 s93, s46, 8
    s_lshl_b32 s93, s93, 4
    s_add_u32 s92, s92, s93
    s_add_u32 s93, s92, 4096
    buffer_store_dwordx4 v[224:227], v157, s[4:7], s92 offen offset:0 sc1
    buffer_store_dwordx4 v[232:235], v157, s[4:7], s92 offen offset:2048 sc1
    buffer_store_dwordx4 v[240:243], v157, s[4:7], s93 offen offset:0 sc1
    buffer_store_dwordx4 v[248:251], v157, s[4:7], s93 offen offset:2048 sc1
    s_branch L_hook_ret
L_h_compV:
    ds_read_b128 v[112:115], v142
    ds_read_b128 v[116:119], v142 offset:1024
    v_and_b32 v140, 15, v0
    v_bfe_u32 v141, v0, 4, 2
    v_lshlrev_b32 v158, 12, v141
    v_lshl_add_u32 v158, v140, 4, v158
    v_and_b32 v157, 63, v0
    v_lshlrev_b32 v157, 4, v157
    s_waitcnt lgkmcnt(0)
    v_lshlrev_b32 v120, 16, v112
    v_lshlrev_b32 v121, 16, v116
    v_and_b32 v122, s34, v112
    v_and_b32 v123, s34, v116
    v_lshlrev_b32 v124, 16, v113
    v_lshlrev_b32 v125, 16, v117
    v_and_b32 v126, s34, v113
    v_and_b32 v127, s34, v117
    v_lshlrev_b32 v128, 16, v114
    v_lshlrev_b32 v129, 16, v118
    v_and_b32 v130, s34, v114
    v_and_b32 v131, s34, v118
    v_lshlrev_b32 v132, 16, v115
    v_lshlrev_b32 v133, 16, v119
    v_and_b32 v134, s34, v115
    v_and_b32 v135, s34, v119
    v_cvt_f32_i32 v224, v224
    v_cvt_f32_i32 v225, v225
    v_cvt_f32_i32 v226, v226
    v_cvt_f32_i32 v227, v227
    v_cvt_f32_i32 v228, v228
    v_cvt_f32_i32 v229, v229
    v_cvt_f32_i32 v230, v230
    v_cvt_f32_i32 v231, v231
    v_cvt_f32_i32 v232, v232
    v_cvt_f32_i32 v233, v233
    v_cvt_f32_i32 v234, v234
    v_cvt_f32_i32 v235, v235
    v_cvt_f32_i32 v236, v236
    v_cvt_f32_i32 v237, v237
    v_cvt_f32_i32 v238, v238
    v_cvt_f32_i32 v239, v239
    v_cvt_f32_i32 v240, v240
    v_cvt_f32_i32 v241, v241
    v_cvt_f32_i32 v242, v242
    v_cvt_f32_i32 v243, v243
    v_cvt_f32_i32 v244, v244
    v_cvt_f32_i32 v245, v245
    v_cvt_f32_i32 v246, v246
    v_cvt_f32_i32 v247, v247
    v_cvt_f32_i32 v248, v248
    v_cvt_f32_i32 v249, v249
    v_cvt_f32_i32 v250, v250
    v_cvt_f32_i32 v251, v251
    v_cvt_f32_i32 v252, v252
    v_cvt_f32_i32 v253, v253
    v_cvt_f32_i32 v254, v254
    v_cvt_f32_i32 v255, v255
    v_mul_f32 v121, v121, v120
    v_mul_f32 v123, v123, v122
    v_mul_f32 v125, v125, v124
    v_mul_f32 v127, v127, v126
    v_mul_f32 v129, v129, v128
    v_mul_f32 v131, v131, v130
    v_mul_f32 v133, v133, v132
    v_mul_f32 v135, v135, v134
    v_pk_fma_f32 v[224:225], v[224:225], v[120:121], v[120:121] op_sel:[0,0,1] op_sel_hi:[1,0,1] neg_lo:[0,0,1] neg_hi:[0,0,1]
    v_pk_fma_f32 v[226:227], v[226:227], v[120:121], v[120:121] op_sel:[0,0,1] op_sel_hi:[1,0,1] neg_lo:[0,0,1] neg_hi:[0,0,1]
    v_pk_fma_f32 v[228:229], v[228:229], v[122:123], v[122:123] op_sel:[0,0,1] op_sel_hi:[1,0,1] neg_lo:[0,0,1] neg_hi:[0,0,1]
    v_pk_fma_f32 v[230:231], v[230:231], v[122:123], v[122:123] op_sel:[0,0,1] op_sel_hi:[1,0,1] neg_lo:[0,0,1] neg_hi:[0,0,1]
    v_pk_fma_f32 v[232:233], v[232:233], v[124:125], v[124:125] op_sel:[0,0,1] op_sel_hi:[1,0,1] neg_lo:[0,0,1] neg_hi:[0,0,1]
    v_pk_fma_f32 v[234:235], v[234:235], v[124:125], v[124:125] op_sel:[0,0,1] op_sel_hi:[1,0,1] neg_lo:[0,0,1] neg_hi:[0,0,1]
    v_pk_fma_f32 v[236:237], v[236:237], v[126:127], v[126:127] op_sel:[0,0,1] op_sel_hi:[1,0,1] neg_lo:[0,0,1] neg_hi:[0,0,1]
    v_pk_fma_f32 v[238:239], v[238:239], v[126:127], v[126:127] op_sel:[0,0,1] op_sel_hi:[1,0,1] neg_lo:[0,0,1] neg_hi:[0,0,1]
    v_pk_fma_f32 v[240:241], v[240:241], v[128:129], v[128:129] op_sel:[0,0,1] op_sel_hi:[1,0,1] neg_lo:[0,0,1] neg_hi:[0,0,1]
    v_pk_fma_f32 v[242:243], v[242:243], v[128:129], v[128:129] op_sel:[0,0,1] op_sel_hi:[1,0,1] neg_lo:[0,0,1] neg_hi:[0,0,1]
    v_pk_fma_f32 v[244:245], v[244:245], v[130:131], v[130:131] op_sel:[0,0,1] op_sel_hi:[1,0,1] neg_lo:[0,0,1] neg_hi:[0,0,1]
    v_pk_fma_f32 v[246:247], v[246:247], v[130:131], v[130:131] op_sel:[0,0,1] op_sel_hi:[1,0,1] neg_lo:[0,0,1] neg_hi:[0,0,1]
    v_pk_fma_f32 v[248:249], v[248:249], v[132:133], v[132:133] op_sel:[0,0,1] op_sel_hi:[1,0,1] neg_lo:[0,0,1] neg_hi:[0,0,1]
    v_pk_fma_f32 v[250:251], v[250:251], v[132:133], v[132:133] op_sel:[0,0,1] op_sel_hi:[1,0,1] neg_lo:[0,0,1] neg_hi:[0,0,1]
    v_pk_fma_f32 v[252:253], v[252:253], v[134:135], v[134:135] op_sel:[0,0,1] op_sel_hi:[1,0,1] neg_lo:[0,0,1] neg_hi:[0,0,1]
    v_pk_fma_f32 v[254:255], v[254:255], v[134:135], v[134:135] op_sel:[0,0,1] op_sel_hi:[1,0,1] neg_lo:[0,0,1] neg_hi:[0,0,1]
    v_cvt_pk_bf16_f32 v120, v224, v228
    v_cvt_pk_bf16_f32 v121, v232, v236
    v_cvt_pk_bf16_f32 v122, v240, v244
    v_cvt_pk_bf16_f32 v123, v248, v252
    v_cvt_pk_bf16_f32 v124, v225, v229
    v_cvt_pk_bf16_f32 v125, v233, v237
    v_cvt_pk_bf16_f32 v126, v241, v245
    v_cvt_pk_bf16_f32 v127, v249, v253
    v_cvt_pk_bf16_f32 v128, v226, v230
    v_cvt_pk_bf16_f32 v129, v234, v238
    v_cvt_pk_bf16_f32 v130, v242, v246
    v_cvt_pk_bf16_f32 v131, v250, v254
    v_cvt_pk_bf16_f32 v132, v227, v231
    v_cvt_pk_bf16_f32 v133, v235, v239
    v_cvt_pk_bf16_f32 v134, v243, v247
    v_cvt_pk_bf16_f32 v135, v251, v255
    s_lshr_b32 s92, s47, 2
    s_lshl_b32 s92, s92, 16
    s_lshl_b32 s93, s48, 14
    s_add_u32 s92, s92, s93
    s_sub_u32 s93, s47, s48
    s_and_b32 s93, s93, 3
    s_lshl_b32 s93, s93, 10
    s_add_u32 s92, s92, s93
    buffer_store_dwordx4 v[120:123], v157, s[8:11], s92 offen sc1
    s_add_u32 s92, s92, 4096
    buffer_store_dwordx4 v[124:127], v157, s[8:11], s92 offen sc1
    s_add_u32 s92, s92, 4096
    buffer_store_dwordx4 v[128:131], v157, s[8:11], s92 offen sc1
    s_add_u32 s92, s92, 4096
    buffer_store_dwordx4 v[132:135], v157, s[8:11], s92 offen sc1
L_hook_ret:
    s_setpc_b64 s[66:67]
L_slow:
    s_waitcnt vmcnt(0) lgkmcnt(0)
    s_nop 15
    s_barrier
    v_accvgpr_write_b32 a0, 0
    v_accvgpr_write_b32 a1, 0
    v_accvgpr_write_b32 a2, 0
    v_accvgpr_write_b32 a3, 0
    v_accvgpr_write_b32 a4, 0
    v_accvgpr_write_b32 a5, 0
    v_accvgpr_write_b32 a6, 0
    v_accvgpr_write_b32 a7, 0
    v_accvgpr_write_b32 a8, 0
    v_accvgpr_write_b32 a9, 0
    v_accvgpr_write_b32 a10, 0
    v_accvgpr_write_b32 a11, 0
    v_accvgpr_write_b32 a12, 0
    v_accvgpr_write_b32 a13, 0
    v_accvgpr_write_b32 a14, 0
    v_accvgpr_write_b32 a15, 0
    v_accvgpr_write_b32 a16, 0
    v_accvgpr_write_b32 a17, 0
    v_accvgpr_write_b32 a18, 0
    v_accvgpr_write_b32 a19, 0
    v_accvgpr_write_b32 a20, 0
    v_accvgpr_write_b32 a21, 0
    v_accvgpr_write_b32 a22, 0
    v_accvgpr_write_b32 a23, 0
    v_accvgpr_write_b32 a24, 0
    v_accvgpr_write_b32 a25, 0
    v_accvgpr_write_b32 a26, 0
    v_accvgpr_write_b32 a27, 0
    v_accvgpr_write_b32 a28, 0
    v_accvgpr_write_b32 a29, 0
    v_accvgpr_write_b32 a30, 0
    v_accvgpr_write_b32 a31, 0
    v_accvgpr_write_b32 a32, 0
    v_accvgpr_write_b32 a33, 0
    v_accvgpr_write_b32 a34, 0
    v_accvgpr_write_b32 a35, 0
    v_accvgpr_write_b32 a36, 0
    v_accvgpr_write_b32 a37, 0
    v_accvgpr_write_b32 a38, 0
    v_accvgpr_write_b32 a39, 0
    v_accvgpr_write_b32 a40, 0
    v_accvgpr_write_b32 a41, 0
    v_accvgpr_write_b32 a42, 0
    v_accvgpr_write_b32 a43, 0
    v_accvgpr_write_b32 a44, 0
    v_accvgpr_write_b32 a45, 0
    v_accvgpr_write_b32 a46, 0
    v_accvgpr_write_b32 a47, 0
    v_accvgpr_write_b32 a48, 0
    v_accvgpr_write_b32 a49, 0
    v_accvgpr_write_b32 a50, 0
    v_accvgpr_write_b32 a51, 0
    v_accvgpr_write_b32 a52, 0
    v_accvgpr_write_b32 a53, 0
    v_accvgpr_write_b32 a54, 0
    v_accvgpr_write_b32 a55, 0
    v_accvgpr_write_b32 a56, 0
    v_accvgpr_write_b32 a57, 0
    v_accvgpr_write_b32 a58, 0
    v_accvgpr_write_b32 a59, 0
    v_accvgpr_write_b32 a60, 0
    v_accvgpr_write_b32 a61, 0
    v_accvgpr_write_b32 a62, 0
    v_accvgpr_write_b32 a63, 0
    v_mov_b32 v9, 0
    v_mov_b32 v48, 0xff7fffff
    v_mov_b32 v10, 0
    v_mov_b32 v49, 0xff7fffff
    v_mov_b32 v11, 0
    v_mov_b32 v50, 0xff7fffff
    v_mov_b32 v12, 0
    v_mov_b32 v51, 0xff7fffff
    s_mov_b32 s30, 0
L_slow_loop:
    s_lshl_b32 s35, s30, 16
    s_mov_b32 s29, s35
    buffer_load_dwordx4 a[192:195], v1, s[4:7], s35 offen offset:0 sc1
    buffer_load_dwordx4 a[196:199], v1, s[4:7], s35 offen offset:1024 sc1
    buffer_load_dwordx4 a[200:203], v1, s[4:7], s35 offen offset:2048 sc1
    buffer_load_dwordx4 a[204:207], v1, s[4:7], s35 offen offset:3072 sc1
    buffer_load_dwordx4 a[208:211], v2, s[4:7], s35 offen offset:0 sc1
    buffer_load_dwordx4 a[212:215], v2, s[4:7], s35 offen offset:1024 sc1
    buffer_load_dwordx4 a[216:219], v2, s[4:7], s35 offen offset:2048 sc1
    buffer_load_dwordx4 a[220:223], v2, s[4:7], s35 offen offset:3072 sc1
    buffer_load_dwordx4 a[224:227], v3, s[4:7], s35 offen offset:0 sc1
    buffer_load_dwordx4 a[228:231], v3, s[4:7], s35 offen offset:1024 sc1
    buffer_load_dwordx4 a[232:235], v3, s[4:7], s35 offen offset:2048 sc1
    buffer_load_dwordx4 a[236:239], v3, s[4:7], s35 offen offset:3072 sc1
    buffer_load_dwordx4 a[240:243], v4, s[4:7], s35 offen offset:0 sc1
    buffer_load_dwordx4 a[244:247], v4, s[4:7], s35 offen offset:1024 sc1
    buffer_load_dwordx4 a[248:251], v4, s[4:7], s35 offen offset:2048 sc1
    buffer_load_dwordx4 a[252:255], v4, s[4:7], s35 offen offset:3072 sc1
    buffer_load_dwordx4 v[160:163], v1, s[8:11], s29 offen offset:0 sc1
    buffer_load_dwordx4 v[164:167], v1, s[8:11], s29 offen offset:1024 sc1
    buffer_load_dwordx4 v[168:171], v1, s[8:11], s29 offen offset:2048 sc1
    buffer_load_dwordx4 v[172:175], v1, s[8:11], s29 offen offset:3072 sc1
    buffer_load_dwordx4 v[176:179], v2, s[8:11], s29 offen offset:0 sc1
    buffer_load_dwordx4 v[180:183], v2, s[8:11], s29 offen offset:1024 sc1
    buffer_load_dwordx4 v[184:187], v2, s[8:11], s29 offen offset:2048 sc1
    buffer_load_dwordx4 v[188:191], v2, s[8:11], s29 offen offset:3072 sc1
    buffer_load_dwordx4 v[192:195], v3, s[8:11], s29 offen offset:0 sc1
    buffer_load_dwordx4 v[196:199], v3, s[8:11], s29 offen offset:1024 sc1
    buffer_load_dwordx4 v[200:203], v3, s[8:11], s29 offen offset:2048 sc1
    buffer_load_dwordx4 v[204:207], v3, s[8:11], s29 offen offset:3072 sc1
    buffer_load_dwordx4 v[208:211], v4, s[8:11], s29 offen offset:0 sc1
    buffer_load_dwordx4 v[212:215], v4, s[8:11], s29 offen offset:1024 sc1
    buffer_load_dwordx4 v[216:219], v4, s[8:11], s29 offen offset:2048 sc1
    buffer_load_dwordx4 v[220:223], v4, s[8:11], s29 offen offset:3072 sc1
    s_waitcnt vmcnt(16)
    v_mfma_f32_16x16x32_bf16 v[16:19], a[192:195], a[64:67], 0
    v_mfma_f32_16x16x32_bf16 v[16:19], a[196:199], a[68:71], v[16:19]
    v_mfma_f32_16x16x32_bf16 v[16:19], a[200:203], a[72:75], v[16:19]
    v_mfma_f32_16x16x32_bf16 v[16:19], a[204:207], a[76:79], v[16:19]
    v_mfma_f32_16x16x32_bf16 v[16:19], a[208:211], a[80:83], v[16:19]
    v_mfma_f32_16x16x32_bf16 v[16:19], a[212:215], a[84:87], v[16:19]
    v_mfma_f32_16x16x32_bf16 v[16:19], a[216:219], a[88:91], v[16:19]
    v_mfma_f32_16x16x32_bf16 v[16:19], a[220:223], a[92:95], v[16:19]
    v_mfma_f32_16x16x32_bf16 v[20:23], a[192:195], a[96:99], 0
    v_mfma_f32_16x16x32_bf16 v[20:23], a[196:199], a[100:103], v[20:23]
    v_mfma_f32_16x16x32_bf16 v[20:23], a[200:203], a[104:107], v[20:23]
    v_mfma_f32_16x16x32_bf16 v[20:23], a[204:207], a[108:111], v[20:23]
    v_mfma_f32_16x16x32_bf16 v[20:23], a[208:211], a[112:115], v[20:23]
    v_mfma_f32_16x16x32_bf16 v[20:23], a[212:215], a[116:119], v[20:23]
    v_mfma_f32_16x16x32_bf16 v[20:23], a[216:219], a[120:123], v[20:23]
    v_mfma_f32_16x16x32_bf16 v[20:23], a[220:223], a[124:127], v[20:23]
    v_mfma_f32_16x16x32_bf16 v[24:27], a[192:195], a[128:131], 0
    v_mfma_f32_16x16x32_bf16 v[24:27], a[196:199], a[132:135], v[24:27]
    v_mfma_f32_16x16x32_bf16 v[24:27], a[200:203], a[136:139], v[24:27]
    v_mfma_f32_16x16x32_bf16 v[24:27], a[204:207], a[140:143], v[24:27]
    v_mfma_f32_16x16x32_bf16 v[24:27], a[208:211], a[144:147], v[24:27]
    v_mfma_f32_16x16x32_bf16 v[24:27], a[212:215], a[148:151], v[24:27]
    v_mfma_f32_16x16x32_bf16 v[24:27], a[216:219], a[152:155], v[24:27]
    v_mfma_f32_16x16x32_bf16 v[24:27], a[220:223], a[156:159], v[24:27]
    v_mfma_f32_16x16x32_bf16 v[28:31], a[192:195], a[160:163], 0
    v_mfma_f32_16x16x32_bf16 v[28:31], a[196:199], a[164:167], v[28:31]
    v_mfma_f32_16x16x32_bf16 v[28:31], a[200:203], a[168:171], v[28:31]
    v_mfma_f32_16x16x32_bf16 v[28:31], a[204:207], a[172:175], v[28:31]
    v_mfma_f32_16x16x32_bf16 v[28:31], a[208:211], a[176:179], v[28:31]
    v_mfma_f32_16x16x32_bf16 v[28:31], a[212:215], a[180:183], v[28:31]
    v_mfma_f32_16x16x32_bf16 v[28:31], a[216:219], a[184:187], v[28:31]
    v_mfma_f32_16x16x32_bf16 v[28:31], a[220:223], a[188:191], v[28:31]
    v_mfma_f32_16x16x32_bf16 v[32:35], a[224:227], a[64:67], 0
    v_mfma_f32_16x16x32_bf16 v[32:35], a[228:231], a[68:71], v[32:35]
    v_mfma_f32_16x16x32_bf16 v[32:35], a[232:235], a[72:75], v[32:35]
    v_mfma_f32_16x16x32_bf16 v[32:35], a[236:239], a[76:79], v[32:35]
    v_mfma_f32_16x16x32_bf16 v[32:35], a[240:243], a[80:83], v[32:35]
    v_mfma_f32_16x16x32_bf16 v[32:35], a[244:247], a[84:87], v[32:35]
    v_mfma_f32_16x16x32_bf16 v[32:35], a[248:251], a[88:91], v[32:35]
    v_mfma_f32_16x16x32_bf16 v[32:35], a[252:255], a[92:95], v[32:35]
    v_mfma_f32_16x16x32_bf16 v[36:39], a[224:227], a[96:99], 0
    v_mfma_f32_16x16x32_bf16 v[36:39], a[228:231], a[100:103], v[36:39]
    v_mfma_f32_16x16x32_bf16 v[36:39], a[232:235], a[104:107], v[36:39]
    v_mfma_f32_16x16x32_bf16 v[36:39], a[236:239], a[108:111], v[36:39]
    v_mfma_f32_16x16x32_bf16 v[36:39], a[240:243], a[112:115], v[36:39]
    v_mfma_f32_16x16x32_bf16 v[36:39], a[244:247], a[116:119], v[36:39]
    v_mfma_f32_16x16x32_bf16 v[36:39], a[248:251], a[120:123], v[36:39]
    v_mfma_f32_16x16x32_bf16 v[36:39], a[252:255], a[124:127], v[36:39]
    v_mfma_f32_16x16x32_bf16 v[40:43], a[224:227], a[128:131], 0
    v_mfma_f32_16x16x32_bf16 v[40:43], a[228:231], a[132:135], v[40:43]
    v_mfma_f32_16x16x32_bf16 v[40:43], a[232:235], a[136:139], v[40:43]
    v_mfma_f32_16x16x32_bf16 v[40:43], a[236:239], a[140:143], v[40:43]
    v_mfma_f32_16x16x32_bf16 v[40:43], a[240:243], a[144:147], v[40:43]
    v_mfma_f32_16x16x32_bf16 v[40:43], a[244:247], a[148:151], v[40:43]
    v_mfma_f32_16x16x32_bf16 v[40:43], a[248:251], a[152:155], v[40:43]
    v_mfma_f32_16x16x32_bf16 v[40:43], a[252:255], a[156:159], v[40:43]
    v_mfma_f32_16x16x32_bf16 v[44:47], a[224:227], a[160:163], 0
    v_mfma_f32_16x16x32_bf16 v[44:47], a[228:231], a[164:167], v[44:47]
    v_mfma_f32_16x16x32_bf16 v[44:47], a[232:235], a[168:171], v[44:47]
    v_mfma_f32_16x16x32_bf16 v[44:47], a[236:239], a[172:175], v[44:47]
    v_mfma_f32_16x16x32_bf16 v[44:47], a[240:243], a[176:179], v[44:47]
    v_mfma_f32_16x16x32_bf16 v[44:47], a[244:247], a[180:183], v[44:47]
    v_mfma_f32_16x16x32_bf16 v[44:47], a[248:251], a[184:187], v[44:47]
    v_mfma_f32_16x16x32_bf16 v[44:47], a[252:255], a[188:191], v[44:47]
    s_nop 15
    v_max3_f32 v52, v16, v17, v18
    v_max3_f32 v52, v52, v19, v32
    v_max3_f32 v52, v52, v33, v34
    v_max_f32 v52, v52, v35
    v_max3_f32 v53, v20, v21, v22
    v_max3_f32 v53, v53, v23, v36
    v_max3_f32 v53, v53, v37, v38
    v_max_f32 v53, v53, v39
    v_max3_f32 v54, v24, v25, v26
    v_max3_f32 v54, v54, v27, v40
    v_max3_f32 v54, v54, v41, v42
    v_max_f32 v54, v54, v43
    v_max3_f32 v55, v28, v29, v30
    v_max3_f32 v55, v55, v31, v44
    v_max3_f32 v55, v55, v45, v46
    v_max_f32 v55, v55, v47
    v_mov_b32 v56, v52
    v_mov_b32 v57, v53
    v_mov_b32 v58, v54
    v_mov_b32 v59, v55
    s_nop 1
    v_permlane32_swap_b32 v56, v52
    v_permlane32_swap_b32 v57, v53
    v_permlane32_swap_b32 v58, v54
    v_permlane32_swap_b32 v59, v55
    s_nop 1
    v_max_f32 v52, v52, v56
    v_max_f32 v53, v53, v57
    v_max_f32 v54, v54, v58
    v_max_f32 v55, v55, v59
    v_mov_b32 v56, v52
    v_mov_b32 v57, v53
    v_mov_b32 v58, v54
    v_mov_b32 v59, v55
    s_nop 1
    v_permlane16_swap_b32 v56, v52
    v_permlane16_swap_b32 v57, v53
    v_permlane16_swap_b32 v58, v54
    v_permlane16_swap_b32 v59, v55
    s_nop 1
    v_max_f32 v52, v52, v56
    v_max_f32 v53, v53, v57
    v_max_f32 v54, v54, v58
    v_max_f32 v55, v55, v59
    ds_write_b32 v231, v52 offset:0
    ds_write_b32 v231, v53 offset:256
    ds_write_b32 v231, v54 offset:512
    ds_write_b32 v231, v55 offset:768
    s_waitcnt lgkmcnt(0)
    s_barrier
    ds_read_b128 v[56:59], v232 offset:0
    ds_read_b128 v[60:63], v232 offset:256
    ds_read_b128 v[64:67], v232 offset:512
    ds_read_b128 v[68:71], v232 offset:768
    s_waitcnt lgkmcnt(0)
    v_max3_f32 v56, v56, v57, v58
    v_max3_f32 v56, v56, v59, v48
    v_sub_f32 v52, v48, v56
    v_mov_b32 v48, v56
    v_max3_f32 v60, v60, v61, v62
    v_max3_f32 v60, v60, v63, v49
    v_sub_f32 v53, v49, v60
    v_mov_b32 v49, v60
    v_max3_f32 v64, v64, v65, v66
    v_max3_f32 v64, v64, v67, v50
    v_sub_f32 v54, v50, v64
    v_mov_b32 v50, v64
    v_max3_f32 v68, v68, v69, v70
    v_max3_f32 v68, v68, v71, v51
    v_sub_f32 v55, v51, v68
    v_mov_b32 v51, v68
    v_exp_f32 v52, v52
    v_exp_f32 v53, v53
    v_exp_f32 v54, v54
    v_exp_f32 v55, v55
    s_nop 0
    v_mul_f32 v9, v9, v52
    v_mul_f32 v10, v10, v53
    v_mul_f32 v11, v11, v54
    v_mul_f32 v12, v12, v55
    v_accvgpr_read_b32 v56, a0
    v_mul_f32 v56, v56, v52
    v_accvgpr_write_b32 a0, v56
    v_accvgpr_read_b32 v56, a1
    v_mul_f32 v56, v56, v52
    v_accvgpr_write_b32 a1, v56
    v_accvgpr_read_b32 v56, a2
    v_mul_f32 v56, v56, v52
    v_accvgpr_write_b32 a2, v56
    v_accvgpr_read_b32 v56, a3
    v_mul_f32 v56, v56, v52
    v_accvgpr_write_b32 a3, v56
    v_accvgpr_read_b32 v56, a4
    v_mul_f32 v56, v56, v53
    v_accvgpr_write_b32 a4, v56
    v_accvgpr_read_b32 v56, a5
    v_mul_f32 v56, v56, v53
    v_accvgpr_write_b32 a5, v56
    v_accvgpr_read_b32 v56, a6
    v_mul_f32 v56, v56, v53
    v_accvgpr_write_b32 a6, v56
    v_accvgpr_read_b32 v56, a7
    v_mul_f32 v56, v56, v53
    v_accvgpr_write_b32 a7, v56
    v_accvgpr_read_b32 v56, a8
    v_mul_f32 v56, v56, v54
    v_accvgpr_write_b32 a8, v56
    v_accvgpr_read_b32 v56, a9
    v_mul_f32 v56, v56, v54
    v_accvgpr_write_b32 a9, v56
    v_accvgpr_read_b32 v56, a10
    v_mul_f32 v56, v56, v54
    v_accvgpr_write_b32 a10, v56
    v_accvgpr_read_b32 v56, a11
    v_mul_f32 v56, v56, v54
    v_accvgpr_write_b32 a11, v56
    v_accvgpr_read_b32 v56, a12
    v_mul_f32 v56, v56, v55
    v_accvgpr_write_b32 a12, v56
    v_accvgpr_read_b32 v56, a13
    v_mul_f32 v56, v56, v55
    v_accvgpr_write_b32 a13, v56
    v_accvgpr_read_b32 v56, a14
    v_mul_f32 v56, v56, v55
    v_accvgpr_write_b32 a14, v56
    v_accvgpr_read_b32 v56, a15
    v_mul_f32 v56, v56, v55
    v_accvgpr_write_b32 a15, v56
    v_accvgpr_read_b32 v56, a16
    v_mul_f32 v56, v56, v52
    v_accvgpr_write_b32 a16, v56
    v_accvgpr_read_b32 v56, a17
    v_mul_f32 v56, v56, v52
    v_accvgpr_write_b32 a17, v56
    v_accvgpr_read_b32 v56, a18
    v_mul_f32 v56, v56, v52
    v_accvgpr_write_b32 a18, v56
    v_accvgpr_read_b32 v56, a19
    v_mul_f32 v56, v56, v52
    v_accvgpr_write_b32 a19, v56
    v_accvgpr_read_b32 v56, a20
    v_mul_f32 v56, v56, v53
    v_accvgpr_write_b32 a20, v56
    v_accvgpr_read_b32 v56, a21
    v_mul_f32 v56, v56, v53
    v_accvgpr_write_b32 a21, v56
    v_accvgpr_read_b32 v56, a22
    v_mul_f32 v56, v56, v53
    v_accvgpr_write_b32 a22, v56
    v_accvgpr_read_b32 v56, a23
    v_mul_f32 v56, v56, v53
    v_accvgpr_write_b32 a23, v56
    v_accvgpr_read_b32 v56, a24
    v_mul_f32 v56, v56, v54
    v_accvgpr_write_b32 a24, v56
    v_accvgpr_read_b32 v56, a25
    v_mul_f32 v56, v56, v54
    v_accvgpr_write_b32 a25, v56
    v_accvgpr_read_b32 v56, a26
    v_mul_f32 v56, v56, v54
    v_accvgpr_write_b32 a26, v56
    v_accvgpr_read_b32 v56, a27
    v_mul_f32 v56, v56, v54
    v_accvgpr_write_b32 a27, v56
    v_accvgpr_read_b32 v56, a28
    v_mul_f32 v56, v56, v55
    v_accvgpr_write_b32 a28, v56
    v_accvgpr_read_b32 v56, a29
    v_mul_f32 v56, v56, v55
    v_accvgpr_write_b32 a29, v56
    v_accvgpr_read_b32 v56, a30
    v_mul_f32 v56, v56, v55
    v_accvgpr_write_b32 a30, v56
    v_accvgpr_read_b32 v56, a31
    v_mul_f32 v56, v56, v55
    v_accvgpr_write_b32 a31, v56
    v_accvgpr_read_b32 v56, a32
    v_mul_f32 v56, v56, v52
    v_accvgpr_write_b32 a32, v56
    v_accvgpr_read_b32 v56, a33
    v_mul_f32 v56, v56, v52
    v_accvgpr_write_b32 a33, v56
    v_accvgpr_read_b32 v56, a34
    v_mul_f32 v56, v56, v52
    v_accvgpr_write_b32 a34, v56
    v_accvgpr_read_b32 v56, a35
    v_mul_f32 v56, v56, v52
    v_accvgpr_write_b32 a35, v56
    v_accvgpr_read_b32 v56, a36
    v_mul_f32 v56, v56, v53
    v_accvgpr_write_b32 a36, v56
    v_accvgpr_read_b32 v56, a37
    v_mul_f32 v56, v56, v53
    v_accvgpr_write_b32 a37, v56
    v_accvgpr_read_b32 v56, a38
    v_mul_f32 v56, v56, v53
    v_accvgpr_write_b32 a38, v56
    v_accvgpr_read_b32 v56, a39
    v_mul_f32 v56, v56, v53
    v_accvgpr_write_b32 a39, v56
    v_accvgpr_read_b32 v56, a40
    v_mul_f32 v56, v56, v54
    v_accvgpr_write_b32 a40, v56
    v_accvgpr_read_b32 v56, a41
    v_mul_f32 v56, v56, v54
    v_accvgpr_write_b32 a41, v56
    v_accvgpr_read_b32 v56, a42
    v_mul_f32 v56, v56, v54
    v_accvgpr_write_b32 a42, v56
    v_accvgpr_read_b32 v56, a43
    v_mul_f32 v56, v56, v54
    v_accvgpr_write_b32 a43, v56
    v_accvgpr_read_b32 v56, a44
    v_mul_f32 v56, v56, v55
    v_accvgpr_write_b32 a44, v56
    v_accvgpr_read_b32 v56, a45
    v_mul_f32 v56, v56, v55
    v_accvgpr_write_b32 a45, v56
    v_accvgpr_read_b32 v56, a46
    v_mul_f32 v56, v56, v55
    v_accvgpr_write_b32 a46, v56
    v_accvgpr_read_b32 v56, a47
    v_mul_f32 v56, v56, v55
    v_accvgpr_write_b32 a47, v56
    v_accvgpr_read_b32 v56, a48
    v_mul_f32 v56, v56, v52
    v_accvgpr_write_b32 a48, v56
    v_accvgpr_read_b32 v56, a49
    v_mul_f32 v56, v56, v52
    v_accvgpr_write_b32 a49, v56
    v_accvgpr_read_b32 v56, a50
    v_mul_f32 v56, v56, v52
    v_accvgpr_write_b32 a50, v56
    v_accvgpr_read_b32 v56, a51
    v_mul_f32 v56, v56, v52
    v_accvgpr_write_b32 a51, v56
    v_accvgpr_read_b32 v56, a52
    v_mul_f32 v56, v56, v53
    v_accvgpr_write_b32 a52, v56
    v_accvgpr_read_b32 v56, a53
    v_mul_f32 v56, v56, v53
    v_accvgpr_write_b32 a53, v56
    v_accvgpr_read_b32 v56, a54
    v_mul_f32 v56, v56, v53
    v_accvgpr_write_b32 a54, v56
    v_accvgpr_read_b32 v56, a55
    v_mul_f32 v56, v56, v53
    v_accvgpr_write_b32 a55, v56
    v_accvgpr_read_b32 v56, a56
    v_mul_f32 v56, v56, v54
    v_accvgpr_write_b32 a56, v56
    v_accvgpr_read_b32 v56, a57
    v_mul_f32 v56, v56, v54
    v_accvgpr_write_b32 a57, v56
    v_accvgpr_read_b32 v56, a58
    v_mul_f32 v56, v56, v54
    v_accvgpr_write_b32 a58, v56
    v_accvgpr_read_b32 v56, a59
    v_mul_f32 v56, v56, v54
    v_accvgpr_write_b32 a59, v56
    v_accvgpr_read_b32 v56, a60
    v_mul_f32 v56, v56, v55
    v_accvgpr_write_b32 a60, v56
    v_accvgpr_read_b32 v56, a61
    v_mul_f32 v56, v56, v55
    v_accvgpr_write_b32 a61, v56
    v_accvgpr_read_b32 v56, a62
    v_mul_f32 v56, v56, v55
    v_accvgpr_write_b32 a62, v56
    v_accvgpr_read_b32 v56, a63
    v_mul_f32 v56, v56, v55
    v_accvgpr_write_b32 a63, v56
    v_sub_f32 v16, v16, v48
    v_sub_f32 v17, v17, v48
    v_sub_f32 v18, v18, v48
    v_sub_f32 v19, v19, v48
    v_sub_f32 v32, v32, v48
    v_sub_f32 v33, v33, v48
    v_sub_f32 v34, v34, v48
    v_sub_f32 v35, v35, v48
    v_exp_f32 v16, v16
    v_exp_f32 v17, v17
    v_exp_f32 v18, v18
    v_exp_f32 v19, v19
    v_exp_f32 v32, v32
    v_exp_f32 v33, v33
    v_exp_f32 v34, v34
    v_exp_f32 v35, v35
    s_nop 0
    v_add_f32 v9, v9, v16
    v_add_f32 v9, v9, v17
    v_add_f32 v9, v9, v18
    v_add_f32 v9, v9, v19
    v_add_f32 v9, v9, v32
    v_add_f32 v9, v9, v33
    v_add_f32 v9, v9, v34
    v_add_f32 v9, v9, v35
    v_cvt_pk_bf16_f32 v80, v16, v17
    v_cvt_pk_bf16_f32 v81, v18, v19
    v_cvt_pk_bf16_f32 v82, v32, v33
    v_cvt_pk_bf16_f32 v83, v34, v35
    ds_write_b128 v5, v[80:83] offset:0
    v_sub_f32 v20, v20, v49
    v_sub_f32 v21, v21, v49
    v_sub_f32 v22, v22, v49
    v_sub_f32 v23, v23, v49
    v_sub_f32 v36, v36, v49
    v_sub_f32 v37, v37, v49
    v_sub_f32 v38, v38, v49
    v_sub_f32 v39, v39, v49
    v_exp_f32 v20, v20
    v_exp_f32 v21, v21
    v_exp_f32 v22, v22
    v_exp_f32 v23, v23
    v_exp_f32 v36, v36
    v_exp_f32 v37, v37
    v_exp_f32 v38, v38
    v_exp_f32 v39, v39
    s_nop 0
    v_add_f32 v10, v10, v20
    v_add_f32 v10, v10, v21
    v_add_f32 v10, v10, v22
    v_add_f32 v10, v10, v23
    v_add_f32 v10, v10, v36
    v_add_f32 v10, v10, v37
    v_add_f32 v10, v10, v38
    v_add_f32 v10, v10, v39
    v_cvt_pk_bf16_f32 v84, v20, v21
    v_cvt_pk_bf16_f32 v85, v22, v23
    v_cvt_pk_bf16_f32 v86, v36, v37
    v_cvt_pk_bf16_f32 v87, v38, v39
    ds_write_b128 v5, v[84:87] offset:1024
    v_sub_f32 v24, v24, v50
    v_sub_f32 v25, v25, v50
    v_sub_f32 v26, v26, v50
    v_sub_f32 v27, v27, v50
    v_sub_f32 v40, v40, v50
    v_sub_f32 v41, v41, v50
    v_sub_f32 v42, v42, v50
    v_sub_f32 v43, v43, v50
    v_exp_f32 v24, v24
    v_exp_f32 v25, v25
    v_exp_f32 v26, v26
    v_exp_f32 v27, v27
    v_exp_f32 v40, v40
    v_exp_f32 v41, v41
    v_exp_f32 v42, v42
    v_exp_f32 v43, v43
    s_nop 0
    v_add_f32 v11, v11, v24
    v_add_f32 v11, v11, v25
    v_add_f32 v11, v11, v26
    v_add_f32 v11, v11, v27
    v_add_f32 v11, v11, v40
    v_add_f32 v11, v11, v41
    v_add_f32 v11, v11, v42
    v_add_f32 v11, v11, v43
    v_cvt_pk_bf16_f32 v88, v24, v25
    v_cvt_pk_bf16_f32 v89, v26, v27
    v_cvt_pk_bf16_f32 v90, v40, v41
    v_cvt_pk_bf16_f32 v91, v42, v43
    ds_write_b128 v5, v[88:91] offset:2048
    v_sub_f32 v28, v28, v51
    v_sub_f32 v29, v29, v51
    v_sub_f32 v30, v30, v51
    v_sub_f32 v31, v31, v51
    v_sub_f32 v44, v44, v51
    v_sub_f32 v45, v45, v51
    v_sub_f32 v46, v46, v51
    v_sub_f32 v47, v47, v51
    v_exp_f32 v28, v28
    v_exp_f32 v29, v29
    v_exp_f32 v30, v30
    v_exp_f32 v31, v31
    v_exp_f32 v44, v44
    v_exp_f32 v45, v45
    v_exp_f32 v46, v46
    v_exp_f32 v47, v47
    s_nop 0
    v_add_f32 v12, v12, v28
    v_add_f32 v12, v12, v29
    v_add_f32 v12, v12, v30
    v_add_f32 v12, v12, v31
    v_add_f32 v12, v12, v44
    v_add_f32 v12, v12, v45
    v_add_f32 v12, v12, v46
    v_add_f32 v12, v12, v47
    v_cvt_pk_bf16_f32 v92, v28, v29
    v_cvt_pk_bf16_f32 v93, v30, v31
    v_cvt_pk_bf16_f32 v94, v44, v45
    v_cvt_pk_bf16_f32 v95, v46, v47
    ds_write_b128 v5, v[92:95] offset:3072
    s_waitcnt lgkmcnt(0)
    s_barrier
    ds_read_b128 v[112:115], v6 offset:0
    ds_read_b128 v[116:119], v6 offset:1024
    ds_read_b128 v[120:123], v6 offset:2048
    ds_read_b128 v[124:127], v6 offset:3072
    ds_read_b128 v[128:131], v7 offset:0
    ds_read_b128 v[132:135], v7 offset:1024
    ds_read_b128 v[136:139], v7 offset:2048
    ds_read_b128 v[140:143], v7 offset:3072
    ds_read_b128 v[144:147], v8 offset:0
    ds_read_b128 v[148:151], v8 offset:1024
    ds_read_b128 v[152:155], v8 offset:2048
    ds_read_b128 v[156:159], v8 offset:3072
    s_waitcnt vmcnt(0) lgkmcnt(0)
    v_mfma_f32_16x16x32_bf16 a[0:3], v[160:163], v[80:83], a[0:3]
    v_mfma_f32_16x16x32_bf16 a[0:3], v[164:167], v[112:115], a[0:3]
    v_mfma_f32_16x16x32_bf16 a[0:3], v[168:171], v[128:131], a[0:3]
    v_mfma_f32_16x16x32_bf16 a[0:3], v[172:175], v[144:147], a[0:3]
    v_mfma_f32_16x16x32_bf16 a[4:7], v[160:163], v[84:87], a[4:7]
    v_mfma_f32_16x16x32_bf16 a[4:7], v[164:167], v[116:119], a[4:7]
    v_mfma_f32_16x16x32_bf16 a[4:7], v[168:171], v[132:135], a[4:7]
    v_mfma_f32_16x16x32_bf16 a[4:7], v[172:175], v[148:151], a[4:7]
    v_mfma_f32_16x16x32_bf16 a[8:11], v[160:163], v[88:91], a[8:11]
    v_mfma_f32_16x16x32_bf16 a[8:11], v[164:167], v[120:123], a[8:11]
    v_mfma_f32_16x16x32_bf16 a[8:11], v[168:171], v[136:139], a[8:11]
    v_mfma_f32_16x16x32_bf16 a[8:11], v[172:175], v[152:155], a[8:11]
    v_mfma_f32_16x16x32_bf16 a[12:15], v[160:163], v[92:95], a[12:15]
    v_mfma_f32_16x16x32_bf16 a[12:15], v[164:167], v[124:127], a[12:15]
    v_mfma_f32_16x16x32_bf16 a[12:15], v[168:171], v[140:143], a[12:15]
    v_mfma_f32_16x16x32_bf16 a[12:15], v[172:175], v[156:159], a[12:15]
    v_mfma_f32_16x16x32_bf16 a[16:19], v[176:179], v[80:83], a[16:19]
    v_mfma_f32_16x16x32_bf16 a[16:19], v[180:183], v[112:115], a[16:19]
    v_mfma_f32_16x16x32_bf16 a[16:19], v[184:187], v[128:131], a[16:19]
    v_mfma_f32_16x16x32_bf16 a[16:19], v[188:191], v[144:147], a[16:19]
    v_mfma_f32_16x16x32_bf16 a[20:23], v[176:179], v[84:87], a[20:23]
    v_mfma_f32_16x16x32_bf16 a[20:23], v[180:183], v[116:119], a[20:23]
    v_mfma_f32_16x16x32_bf16 a[20:23], v[184:187], v[132:135], a[20:23]
    v_mfma_f32_16x16x32_bf16 a[20:23], v[188:191], v[148:151], a[20:23]
    v_mfma_f32_16x16x32_bf16 a[24:27], v[176:179], v[88:91], a[24:27]
    v_mfma_f32_16x16x32_bf16 a[24:27], v[180:183], v[120:123], a[24:27]
    v_mfma_f32_16x16x32_bf16 a[24:27], v[184:187], v[136:139], a[24:27]
    v_mfma_f32_16x16x32_bf16 a[24:27], v[188:191], v[152:155], a[24:27]
    v_mfma_f32_16x16x32_bf16 a[28:31], v[176:179], v[92:95], a[28:31]
    v_mfma_f32_16x16x32_bf16 a[28:31], v[180:183], v[124:127], a[28:31]
    v_mfma_f32_16x16x32_bf16 a[28:31], v[184:187], v[140:143], a[28:31]
    v_mfma_f32_16x16x32_bf16 a[28:31], v[188:191], v[156:159], a[28:31]
    v_mfma_f32_16x16x32_bf16 a[32:35], v[192:195], v[80:83], a[32:35]
    v_mfma_f32_16x16x32_bf16 a[32:35], v[196:199], v[112:115], a[32:35]
    v_mfma_f32_16x16x32_bf16 a[32:35], v[200:203], v[128:131], a[32:35]
    v_mfma_f32_16x16x32_bf16 a[32:35], v[204:207], v[144:147], a[32:35]
    v_mfma_f32_16x16x32_bf16 a[36:39], v[192:195], v[84:87], a[36:39]
    v_mfma_f32_16x16x32_bf16 a[36:39], v[196:199], v[116:119], a[36:39]
    v_mfma_f32_16x16x32_bf16 a[36:39], v[200:203], v[132:135], a[36:39]
    v_mfma_f32_16x16x32_bf16 a[36:39], v[204:207], v[148:151], a[36:39]
    v_mfma_f32_16x16x32_bf16 a[40:43], v[192:195], v[88:91], a[40:43]
    v_mfma_f32_16x16x32_bf16 a[40:43], v[196:199], v[120:123], a[40:43]
    v_mfma_f32_16x16x32_bf16 a[40:43], v[200:203], v[136:139], a[40:43]
    v_mfma_f32_16x16x32_bf16 a[40:43], v[204:207], v[152:155], a[40:43]
    v_mfma_f32_16x16x32_bf16 a[44:47], v[192:195], v[92:95], a[44:47]
    v_mfma_f32_16x16x32_bf16 a[44:47], v[196:199], v[124:127], a[44:47]
    v_mfma_f32_16x16x32_bf16 a[44:47], v[200:203], v[140:143], a[44:47]
    v_mfma_f32_16x16x32_bf16 a[44:47], v[204:207], v[156:159], a[44:47]
    v_mfma_f32_16x16x32_bf16 a[48:51], v[208:211], v[80:83], a[48:51]
    v_mfma_f32_16x16x32_bf16 a[48:51], v[212:215], v[112:115], a[48:51]
    v_mfma_f32_16x16x32_bf16 a[48:51], v[216:219], v[128:131], a[48:51]
    v_mfma_f32_16x16x32_bf16 a[48:51], v[220:223], v[144:147], a[48:51]
    v_mfma_f32_16x16x32_bf16 a[52:55], v[208:211], v[84:87], a[52:55]
    v_mfma_f32_16x16x32_bf16 a[52:55], v[212:215], v[116:119], a[52:55]
    v_mfma_f32_16x16x32_bf16 a[52:55], v[216:219], v[132:135], a[52:55]
    v_mfma_f32_16x16x32_bf16 a[52:55], v[220:223], v[148:151], a[52:55]
    v_mfma_f32_16x16x32_bf16 a[56:59], v[208:211], v[88:91], a[56:59]
    v_mfma_f32_16x16x32_bf16 a[56:59], v[212:215], v[120:123], a[56:59]
    v_mfma_f32_16x16x32_bf16 a[56:59], v[216:219], v[136:139], a[56:59]
    v_mfma_f32_16x16x32_bf16 a[56:59], v[220:223], v[152:155], a[56:59]
    v_mfma_f32_16x16x32_bf16 a[60:63], v[208:211], v[92:95], a[60:63]
    v_mfma_f32_16x16x32_bf16 a[60:63], v[212:215], v[124:127], a[60:63]
    v_mfma_f32_16x16x32_bf16 a[60:63], v[216:219], v[140:143], a[60:63]
    v_mfma_f32_16x16x32_bf16 a[60:63], v[220:223], v[156:159], a[60:63]
    s_nop 15
    s_barrier
    s_add_u32 s30, s30, 1
    s_cmp_lt_u32 s30, 16
    s_cbranch_scc1 L_slow_loop
    v_mov_b32 v56, v9
    v_mov_b32 v57, v10
    v_mov_b32 v58, v11
    v_mov_b32 v59, v12
    s_nop 1
    v_permlane32_swap_b32 v56, v9
    v_permlane32_swap_b32 v57, v10
    v_permlane32_swap_b32 v58, v11
    v_permlane32_swap_b32 v59, v12
    s_nop 1
    v_add_f32 v9, v9, v56
    v_add_f32 v10, v10, v57
    v_add_f32 v11, v11, v58
    v_add_f32 v12, v12, v59
    v_mov_b32 v56, v9
    v_mov_b32 v57, v10
    v_mov_b32 v58, v11
    v_mov_b32 v59, v12
    s_nop 1
    v_permlane16_swap_b32 v56, v9
    v_permlane16_swap_b32 v57, v10
    v_permlane16_swap_b32 v58, v11
    v_permlane16_swap_b32 v59, v12
    s_nop 1
    v_add_f32 v9, v9, v56
    v_add_f32 v10, v10, v57
    v_add_f32 v11, v11, v58
    v_add_f32 v12, v12, v59
    ds_write_b32 v231, v9 offset:0
    ds_write_b32 v231, v10 offset:256
    ds_write_b32 v231, v11 offset:512
    ds_write_b32 v231, v12 offset:768
    s_waitcnt lgkmcnt(0)
    s_barrier
    ds_read_b128 v[240:243], v232 offset:0
    ds_read_b128 v[244:247], v232 offset:256
    ds_read_b128 v[248:251], v232 offset:512
    ds_read_b128 v[252:255], v232 offset:768
    s_waitcnt lgkmcnt(0)
    v_add_f32 v240, v240, v241
    v_add_f32 v242, v242, v243
    v_add_f32 v240, v240, v242
    v_rcp_f32 v240, v240
    v_add_f32 v244, v244, v245
    v_add_f32 v246, v246, v247
    v_add_f32 v244, v244, v246
    v_rcp_f32 v244, v244
    v_add_f32 v248, v248, v249
    v_add_f32 v250, v250, v251
    v_add_f32 v248, v248, v250
    v_rcp_f32 v248, v248
    v_add_f32 v252, v252, v253
    v_add_f32 v254, v254, v255
    v_add_f32 v252, v252, v254
    v_rcp_f32 v252, v252
    s_nop 0
    s_mov_b32 s92, 0
    v_accvgpr_read_b32 v56, a0
    v_accvgpr_read_b32 v57, a16
    v_mul_f32 v56, v56, v240
    v_mul_f32 v57, v57, v240
    v_cvt_pk_bf16_f32 v16, v56, v57
    v_accvgpr_read_b32 v56, a32
    v_accvgpr_read_b32 v57, a48
    v_mul_f32 v56, v56, v240
    v_mul_f32 v57, v57, v240
    v_cvt_pk_bf16_f32 v17, v56, v57
    v_accvgpr_read_b32 v56, a1
    v_accvgpr_read_b32 v57, a17
    v_mul_f32 v56, v56, v240
    v_mul_f32 v57, v57, v240
    v_cvt_pk_bf16_f32 v18, v56, v57
    v_accvgpr_read_b32 v56, a33
    v_accvgpr_read_b32 v57, a49
    v_mul_f32 v56, v56, v240
    v_mul_f32 v57, v57, v240
    v_cvt_pk_bf16_f32 v19, v56, v57
    buffer_store_dwordx4 v[16:19], v234, s[24:27], s92 offen offset:0
    s_nop 1
    v_accvgpr_read_b32 v56, a2
    v_accvgpr_read_b32 v57, a18
    v_mul_f32 v56, v56, v240
    v_mul_f32 v57, v57, v240
    v_cvt_pk_bf16_f32 v20, v56, v57
    v_accvgpr_read_b32 v56, a34
    v_accvgpr_read_b32 v57, a50
    v_mul_f32 v56, v56, v240
    v_mul_f32 v57, v57, v240
    v_cvt_pk_bf16_f32 v21, v56, v57
    v_accvgpr_read_b32 v56, a3
    v_accvgpr_read_b32 v57, a19
    v_mul_f32 v56, v56, v240
    v_mul_f32 v57, v57, v240
    v_cvt_pk_bf16_f32 v22, v56, v57
    v_accvgpr_read_b32 v56, a35
    v_accvgpr_read_b32 v57, a51
    v_mul_f32 v56, v56, v240
    v_mul_f32 v57, v57, v240
    v_cvt_pk_bf16_f32 v23, v56, v57
    buffer_store_dwordx4 v[20:23], v234, s[24:27], s92 offen offset:16
    s_nop 1
    s_mov_b32 s92, 8192
    v_accvgpr_read_b32 v56, a4
    v_accvgpr_read_b32 v57, a20
    v_mul_f32 v56, v56, v244
    v_mul_f32 v57, v57, v244
    v_cvt_pk_bf16_f32 v16, v56, v57
    v_accvgpr_read_b32 v56, a36
    v_accvgpr_read_b32 v57, a52
    v_mul_f32 v56, v56, v244
    v_mul_f32 v57, v57, v244
    v_cvt_pk_bf16_f32 v17, v56, v57
    v_accvgpr_read_b32 v56, a5
    v_accvgpr_read_b32 v57, a21
    v_mul_f32 v56, v56, v244
    v_mul_f32 v57, v57, v244
    v_cvt_pk_bf16_f32 v18, v56, v57
    v_accvgpr_read_b32 v56, a37
    v_accvgpr_read_b32 v57, a53
    v_mul_f32 v56, v56, v244
    v_mul_f32 v57, v57, v244
    v_cvt_pk_bf16_f32 v19, v56, v57
    buffer_store_dwordx4 v[16:19], v234, s[24:27], s92 offen offset:0
    s_nop 1
    v_accvgpr_read_b32 v56, a6
    v_accvgpr_read_b32 v57, a22
    v_mul_f32 v56, v56, v244
    v_mul_f32 v57, v57, v244
    v_cvt_pk_bf16_f32 v20, v56, v57
    v_accvgpr_read_b32 v56, a38
    v_accvgpr_read_b32 v57, a54
    v_mul_f32 v56, v56, v244
    v_mul_f32 v57, v57, v244
    v_cvt_pk_bf16_f32 v21, v56, v57
    v_accvgpr_read_b32 v56, a7
    v_accvgpr_read_b32 v57, a23
    v_mul_f32 v56, v56, v244
    v_mul_f32 v57, v57, v244
    v_cvt_pk_bf16_f32 v22, v56, v57
    v_accvgpr_read_b32 v56, a39
    v_accvgpr_read_b32 v57, a55
    v_mul_f32 v56, v56, v244
    v_mul_f32 v57, v57, v244
    v_cvt_pk_bf16_f32 v23, v56, v57
    buffer_store_dwordx4 v[20:23], v234, s[24:27], s92 offen offset:16
    s_nop 1
    s_mov_b32 s92, 16384
    v_accvgpr_read_b32 v56, a8
    v_accvgpr_read_b32 v57, a24
    v_mul_f32 v56, v56, v248
    v_mul_f32 v57, v57, v248
    v_cvt_pk_bf16_f32 v16, v56, v57
    v_accvgpr_read_b32 v56, a40
    v_accvgpr_read_b32 v57, a56
    v_mul_f32 v56, v56, v248
    v_mul_f32 v57, v57, v248
    v_cvt_pk_bf16_f32 v17, v56, v57
    v_accvgpr_read_b32 v56, a9
    v_accvgpr_read_b32 v57, a25
    v_mul_f32 v56, v56, v248
    v_mul_f32 v57, v57, v248
    v_cvt_pk_bf16_f32 v18, v56, v57
    v_accvgpr_read_b32 v56, a41
    v_accvgpr_read_b32 v57, a57
    v_mul_f32 v56, v56, v248
    v_mul_f32 v57, v57, v248
    v_cvt_pk_bf16_f32 v19, v56, v57
    buffer_store_dwordx4 v[16:19], v234, s[24:27], s92 offen offset:0
    s_nop 1
    v_accvgpr_read_b32 v56, a10
    v_accvgpr_read_b32 v57, a26
    v_mul_f32 v56, v56, v248
    v_mul_f32 v57, v57, v248
    v_cvt_pk_bf16_f32 v20, v56, v57
    v_accvgpr_read_b32 v56, a42
    v_accvgpr_read_b32 v57, a58
    v_mul_f32 v56, v56, v248
    v_mul_f32 v57, v57, v248
    v_cvt_pk_bf16_f32 v21, v56, v57
    v_accvgpr_read_b32 v56, a11
    v_accvgpr_read_b32 v57, a27
    v_mul_f32 v56, v56, v248
    v_mul_f32 v57, v57, v248
    v_cvt_pk_bf16_f32 v22, v56, v57
    v_accvgpr_read_b32 v56, a43
    v_accvgpr_read_b32 v57, a59
    v_mul_f32 v56, v56, v248
    v_mul_f32 v57, v57, v248
    v_cvt_pk_bf16_f32 v23, v56, v57
    buffer_store_dwordx4 v[20:23], v234, s[24:27], s92 offen offset:16
    s_nop 1
    s_mov_b32 s92, 24576
    v_accvgpr_read_b32 v56, a12
    v_accvgpr_read_b32 v57, a28
    v_mul_f32 v56, v56, v252
    v_mul_f32 v57, v57, v252
    v_cvt_pk_bf16_f32 v16, v56, v57
    v_accvgpr_read_b32 v56, a44
    v_accvgpr_read_b32 v57, a60
    v_mul_f32 v56, v56, v252
    v_mul_f32 v57, v57, v252
    v_cvt_pk_bf16_f32 v17, v56, v57
    v_accvgpr_read_b32 v56, a13
    v_accvgpr_read_b32 v57, a29
    v_mul_f32 v56, v56, v252
    v_mul_f32 v57, v57, v252
    v_cvt_pk_bf16_f32 v18, v56, v57
    v_accvgpr_read_b32 v56, a45
    v_accvgpr_read_b32 v57, a61
    v_mul_f32 v56, v56, v252
    v_mul_f32 v57, v57, v252
    v_cvt_pk_bf16_f32 v19, v56, v57
    buffer_store_dwordx4 v[16:19], v234, s[24:27], s92 offen offset:0
    s_nop 1
    v_accvgpr_read_b32 v56, a14
    v_accvgpr_read_b32 v57, a30
    v_mul_f32 v56, v56, v252
    v_mul_f32 v57, v57, v252
    v_cvt_pk_bf16_f32 v20, v56, v57
    v_accvgpr_read_b32 v56, a46
    v_accvgpr_read_b32 v57, a62
    v_mul_f32 v56, v56, v252
    v_mul_f32 v57, v57, v252
    v_cvt_pk_bf16_f32 v21, v56, v57
    v_accvgpr_read_b32 v56, a15
    v_accvgpr_read_b32 v57, a31
    v_mul_f32 v56, v56, v252
    v_mul_f32 v57, v57, v252
    v_cvt_pk_bf16_f32 v22, v56, v57
    v_accvgpr_read_b32 v56, a47
    v_accvgpr_read_b32 v57, a63
    v_mul_f32 v56, v56, v252
    v_mul_f32 v57, v57, v252
    v_cvt_pk_bf16_f32 v23, v56, v57
    buffer_store_dwordx4 v[20:23], v234, s[24:27], s92 offen offset:16
    s_nop 1
    s_endpgm
L_done:
    s_endpgm
L_code_end:
.section .rodata,"a"
.p2align 6
.amdhsa_kernel standalone__kv_cache_quant_pre_rope_vs_post_rope__prompt_kernel
  .amdhsa_next_free_vgpr 512
  .amdhsa_next_free_sgpr 102
  .amdhsa_accum_offset 256
  .amdhsa_group_segment_fixed_size 0
  .amdhsa_kernarg_size 112
  .amdhsa_user_sgpr_count 2
  .amdhsa_user_sgpr_kernarg_segment_ptr 1
  .amdhsa_system_sgpr_workgroup_id_x 1
  .amdhsa_float_denorm_mode_32 3
.end_amdhsa_kernel
```
